```python
import torch

def _softmax(x, axis=-1):
    return torch.softmax(x, dim=axis)
def _gelu(x):
    return torch.nn.functional.gelu(x, approximate="tanh")
def _silu(x):
    return torch.nn.functional.silu(x)
def _sigmoid(x):
    return torch.sigmoid(x)
def _layernorm(x, axis=-1, eps=1e-5):
    m = x.mean(dim=axis, keepdim=True)
    v = x.var(dim=axis, keepdim=True, unbiased=False)
    return (x - m) / torch.sqrt(v + eps)
def _scatter_add(tgt, idx, src, axis=0):
    return tgt.clone().index_add_(axis, idx, src)
def _segment_sum(src, seg, n):
    out = torch.zeros((n,) + src.shape[1:], dtype=src.dtype)
    return out.index_add_(0, seg, src)
def _pad(x, pw):
    flat = tuple(v for pair in reversed(pw) for v in pair)
    return torch.nn.functional.pad(x, flat)

kernel_name = 'concat_heads__mha_block_cached__gqa_block_cached__decode'

def setup_inputs():

    _w = (lambda a: (lambda t: t.to(torch.bfloat16) if t.is_floating_point() else t)(torch.as_tensor(a)))
    def _A_setup():
        B, Sq, D = 4, 1, 640
        H, Sk, Dh = 32, 4096, 128
        return {
            "x": _w((lambda *s: torch.randn(*s, dtype=torch.bfloat16) * 0.8)(B, Sq, D)),
            "k_cache": _w((lambda *s: torch.randn(*s, dtype=torch.bfloat16) * 0.8)(B, H, Sk, Dh)),
            "v_cache": _w((lambda *s: torch.randn(*s, dtype=torch.bfloat16) * 0.05)(B, H, Sk, Dh)),
            "wq": _w((lambda *s: torch.randn(*s, dtype=torch.bfloat16) * 0.8)(D, H * Dh) * (D ** -0.5)),
            "wo": _w((lambda *s: torch.randn(*s, dtype=torch.bfloat16) * 0.05)(H * Dh, D) * ((H * Dh) ** -0.5)),
        }
    _A_in = _A_setup()

    def _B_setup():
        B, Sq, D = 4, 1, 640
        Hq, Hkv, Sk, Dh = 32, 32, 4096, 128
        assert Hq % Hkv == 0, (Hq, Hkv)
        return {
            "x": _w((lambda *s: torch.randn(*s, dtype=torch.bfloat16) * 0.8)(B, Sq, D)),
            "k_cache": _w((lambda *s: torch.randn(*s, dtype=torch.bfloat16) * 0.8)(B, Hkv, Sk, Dh)),
            "v_cache": _w((lambda *s: torch.randn(*s, dtype=torch.bfloat16) * 0.05)(B, Hkv, Sk, Dh)),
            "wq": _w((lambda *s: torch.randn(*s, dtype=torch.bfloat16) * 0.8)(D, Hq * Dh) * (D ** -0.5)),
            "wo": _w((lambda *s: torch.randn(*s, dtype=torch.bfloat16) * 0.05)(Hq * Dh, D) * ((Hq * Dh) ** -0.5)),
        }
    _B_in = _B_setup()

    return {
        "A_x": _A_in["x"],
        "A_k_cache": _A_in["k_cache"],
        "A_v_cache": _A_in["v_cache"],
        "A_wq": _A_in["wq"],
        "A_wo": _A_in["wo"],
        "B_x": _B_in["x"],
        "B_k_cache": _B_in["k_cache"],
        "B_v_cache": _B_in["v_cache"],
        "B_wq": _B_in["wq"],
        "B_wo": _B_in["wo"],
    }

def reference(A_x, A_k_cache, A_v_cache, A_wq, A_wo, B_x, B_k_cache, B_v_cache, B_wq, B_wo):
    def _A_ref(x, k_cache, v_cache, wq, wo):
        B, Sq, D = x.shape
        H, Dh = 32, 128
        q = (lambda x, *d: x.permute(*d))((x @ wq).reshape(B, Sq, H, Dh), 0, 2, 1, 3)
        scores = torch.einsum("bhqd,bhkd->bhqk", q, k_cache) * (Dh ** -0.5)
        p = _softmax(scores, axis=-1)
        o = torch.einsum("bhqk,bhkd->bhqd", p, v_cache)
        return (lambda x, *d: x.permute(*d))(o, 0, 2, 1, 3).reshape(B, Sq, H * Dh) @ wo

    def _B_ref(x, k_cache, v_cache, wq, wo):
        B, Sq, D = x.shape
        Hq, Dh = 32, 128
        Hkv = k_cache.shape[1]
        rep = Hq // Hkv
        q = (lambda x, *d: x.permute(*d))((x @ wq).reshape(B, Sq, Hq, Dh), 0, 2, 1, 3)
        k = (lambda x, n, axis: torch.repeat_interleave(x, n, dim=axis))(k_cache, rep, axis=1)
        v = (lambda x, n, axis: torch.repeat_interleave(x, n, dim=axis))(v_cache, rep, axis=1)
        scores = torch.einsum("bhqd,bhkd->bhqk", q, k) * (Dh ** -0.5)
        p = _softmax(scores, axis=-1)
        o = torch.einsum("bhqk,bhkd->bhqd", p, v)
        return (lambda x, *d: x.permute(*d))(o, 0, 2, 1, 3).reshape(B, Sq, Hq * Dh) @ wo

    a = _A_ref(A_x, A_k_cache, A_v_cache, A_wq, A_wo)
    b = _B_ref(B_x, B_k_cache, B_v_cache, B_wq, B_wo)
    return torch.concatenate([a, b], axis=-1)
```

```asm
; @launch grid=(256,1,1) block=(512,1,1) lds=16384
.amdgcn_target "amdgcn-amd-amdhsa--gfx950"
.text
.globl concat_heads__mha_block_cached__gqa_block_cached__decode_kernel
.p2align 8
.type concat_heads__mha_block_cached__gqa_block_cached__decode_kernel,@function
concat_heads__mha_block_cached__gqa_block_cached__decode_kernel:
    s_cmp_ge_u32 s2, 256
    s_cbranch_scc1 L_done
    s_load_dwordx16 s[4:19], s[0:1], 0
    s_load_dwordx4 s[20:23], s[0:1], 64
    s_load_dwordx2 s[48:49], s[0:1], 80
    s_load_dwordx2 s[50:51], s[0:1], 96
    v_lshrrev_b32 v17, 6, v0
    v_and_b32 v18, 63, v0
    v_readfirstlane_b32 s56, v17
    v_lshlrev_b32 v1, 4, v18
    v_lshrrev_b32 v2, 4, v18
    v_and_b32 v3, 15, v0
    s_xor_b32 s3, s2, 1
    s_and_b32 s57, s3, 7
    s_bfe_u32 s59, s2, 0x10003
    s_lshr_b32 s3, s2, 4
    s_lshl_b32 s3, s3, 3
    s_or_b32 s62, s3, s57
    s_and_b32 s3, s62, 31
    s_lshl_b32 s57, s3, 1
    s_lshr_b32 s3, s3, 4
    s_or_b32 s3, s3, s57
    s_and_b32 s3, s3, 31
    s_andn2_b32 s62, s62, 31
    s_or_b32 s62, s62, s3
    s_and_b32 s57, s62, 31
    s_lshr_b32 s58, s62, 5
    s_mov_b32 s46, 0x1f0000
    s_mov_b32 s47, 0x20000
    s_mov_b32 s78, 1835008
    s_cmp_ge_u32 s56, 4
    s_cbranch_scc1 L_helper
    s_lshl_b32 s70, s62, 20
    s_mov_b32 s26, 0x100000
    s_mov_b32 s27, 0x20000
    s_and_b32 s3, s56, 1
    s_mul_i32 s60, s3, 147456
    s_lshl_b32 s3, s3, 12
    v_add_u32 v22, s3, v1
    s_lshr_b32 s3, s56, 1
    s_lshl_b32 s3, s3, 13
    s_lshl_b32 s38, s59, 16
    s_add_u32 s3, s3, s38
    v_add_u32 v22, s3, v22
    s_mov_b32 s63, 16
    s_waitcnt lgkmcnt(0)
    s_add_u32 s24, s6, s70
    s_addc_u32 s25, s7, 0
    buffer_load_dwordx4 v[64:67], v22, s[24:27], s60 offen nt
    buffer_load_dwordx4 v[68:71], v22, s[24:27], s60 offen offset:1024 nt
    buffer_load_dwordx4 v[72:75], v22, s[24:27], s60 offen offset:2048 nt
    buffer_load_dwordx4 v[76:79], v22, s[24:27], s60 offen offset:3072 nt
    s_or_b32 s60, s60, 0x13000
    s_add_u32 s60, s60, 0x4000
    s_and_b32 s60, s60, 0xecfff
    buffer_load_dwordx4 v[80:83], v22, s[24:27], s60 offen nt
    s_add_u32 s28, s8, s70
    s_addc_u32 s29, s9, 0
    s_add_u32 s30, s16, s70
    s_addc_u32 s31, s17, 0
    s_add_u32 s36, s18, s70
    s_addc_u32 s37, s19, 0
    s_mov_b64 s[42:43], s[28:29]
    s_mov_b32 s40, 32
    s_lshl_b32 s41, s59, 2
    s_add_u32 s41, s41, 28
    s_mul_i32 s38, s56, 0
    s_add_u32 s38, s38, 16384
    v_add_u32 v25, s38, v1
    s_barrier
    s_mov_b32 s44, s50
    s_mov_b32 s45, s51
    s_mov_b32 s64, 0xcccccccc
    s_mov_b32 s65, 0xcccccccc
    s_mov_b32 s66, 0xaaaaaaaa
    s_mov_b32 s67, 0xaaaaaaaa
    v_and_b32 v17, 1, v3
    v_lshlrev_b32 v17, 4, v17
    v_mov_b32 v18, 0xffff
    v_lshlrev_b32 v17, v17, v18
    v_lshrrev_b32 v18, 1, v3
    v_cmp_eq_u32 vcc, 0, v18
    s_nop 1
    v_cndmask_b32_e32 v4, 0, v17, vcc
    v_cmp_eq_u32 vcc, 1, v18
    s_nop 1
    v_cndmask_b32_e32 v5, 0, v17, vcc
    v_cmp_eq_u32 vcc, 2, v18
    s_nop 1
    v_cndmask_b32_e32 v6, 0, v17, vcc
    v_cmp_eq_u32 vcc, 3, v18
    s_nop 1
    v_cndmask_b32_e32 v7, 0, v17, vcc
    v_lshlrev_b32 v17, 5, v3
    v_lshl_add_u32 v17, v2, 4, v17
    s_and_b32 s3, s56, 3
    s_lshl_b32 s3, s3, 9
    v_add_u32 v16, s3, v17
    s_mov_b32 s72, 0x3e0293ee
    v_mov_b32 v24, 0
    v_mov_b32 v23, 1
    s_waitcnt vmcnt(4)
    buffer_load_dwordx4 v[84:87], v22, s[24:27], s60 offen offset:1024 nt
    s_waitcnt vmcnt(4)
    buffer_load_dwordx4 v[88:91], v22, s[24:27], s60 offen offset:2048 nt
    s_waitcnt vmcnt(4)
    buffer_load_dwordx4 v[92:95], v22, s[24:27], s60 offen offset:3072 nt
    s_or_b32 s60, s60, 0x13000
    s_add_u32 s60, s60, 0x4000
    s_and_b32 s60, s60, 0xecfff
    s_waitcnt vmcnt(4)
    buffer_load_dwordx4 v[96:99], v22, s[24:27], s60 offen nt
    s_waitcnt vmcnt(4)
    buffer_load_dwordx4 v[100:103], v22, s[24:27], s60 offen offset:1024 nt
    s_waitcnt vmcnt(4)
    buffer_load_dwordx4 v[104:107], v22, s[24:27], s60 offen offset:2048 nt
    s_waitcnt vmcnt(4)
    buffer_load_dwordx4 v[108:111], v22, s[24:27], s60 offen offset:3072 nt
    s_or_b32 s60, s60, 0x13000
    s_add_u32 s60, s60, 0x4000
    s_and_b32 s60, s60, 0xecfff
    s_waitcnt vmcnt(4)
    buffer_load_dwordx4 v[112:115], v22, s[24:27], s60 offen nt
    s_waitcnt vmcnt(4)
    buffer_load_dwordx4 v[116:119], v22, s[24:27], s60 offen offset:1024 nt
    s_waitcnt vmcnt(4)
    buffer_load_dwordx4 v[120:123], v22, s[24:27], s60 offen offset:2048 nt
    s_waitcnt vmcnt(4)
    buffer_load_dwordx4 v[124:127], v22, s[24:27], s60 offen offset:3072 nt
    s_or_b32 s60, s60, 0x13000
    s_add_u32 s60, s60, 0x4000
    s_and_b32 s60, s60, 0xecfff
    s_waitcnt vmcnt(4)
    buffer_load_dwordx4 v[128:131], v22, s[24:27], s60 offen nt
    s_waitcnt vmcnt(4)
    buffer_load_dwordx4 v[132:135], v22, s[24:27], s60 offen offset:1024 nt
    s_waitcnt vmcnt(4)
    buffer_load_dwordx4 v[136:139], v22, s[24:27], s60 offen offset:2048 nt
    s_waitcnt vmcnt(4)
    buffer_load_dwordx4 v[140:143], v22, s[24:27], s60 offen offset:3072 nt
    s_or_b32 s60, s60, 0x13000
    s_add_u32 s60, s60, 0x4000
    s_and_b32 s60, s60, 0xecfff
    s_waitcnt vmcnt(4)
    buffer_load_dwordx4 v[144:147], v22, s[24:27], s60 offen nt
    s_waitcnt vmcnt(4)
    buffer_load_dwordx4 v[148:151], v22, s[24:27], s60 offen offset:1024 nt
    s_waitcnt vmcnt(4)
    buffer_load_dwordx4 v[152:155], v22, s[24:27], s60 offen offset:2048 nt
    s_waitcnt vmcnt(4)
    buffer_load_dwordx4 v[156:159], v22, s[24:27], s60 offen offset:3072 nt
    s_or_b32 s60, s60, 0x13000
    s_add_u32 s60, s60, 0x4000
    s_and_b32 s60, s60, 0xecfff
    s_waitcnt vmcnt(4)
    buffer_load_dwordx4 v[160:163], v22, s[24:27], s60 offen nt
    s_waitcnt vmcnt(4)
    buffer_load_dwordx4 v[164:167], v22, s[24:27], s60 offen offset:1024 nt
    s_waitcnt vmcnt(4)
    buffer_load_dwordx4 v[168:171], v22, s[24:27], s60 offen offset:2048 nt
    s_waitcnt vmcnt(4)
    buffer_load_dwordx4 v[172:175], v22, s[24:27], s60 offen offset:3072 nt
    s_or_b32 s60, s60, 0x13000
    s_add_u32 s60, s60, 0x4000
    s_and_b32 s60, s60, 0xecfff
    s_waitcnt vmcnt(4)
    buffer_load_dwordx4 v[176:179], v22, s[24:27], s60 offen nt
    s_waitcnt vmcnt(4)
    buffer_load_dwordx4 v[180:183], v22, s[24:27], s60 offen offset:1024 nt
    s_waitcnt vmcnt(4)
    buffer_load_dwordx4 v[184:187], v22, s[24:27], s60 offen offset:2048 nt
    s_waitcnt vmcnt(4)
    buffer_load_dwordx4 v[188:191], v22, s[24:27], s60 offen offset:3072 nt
    s_or_b32 s60, s60, 0x13000
    s_add_u32 s60, s60, 0x4000
    s_and_b32 s60, s60, 0xecfff
    s_waitcnt vmcnt(4)
    buffer_load_dwordx4 v[192:195], v22, s[24:27], s60 offen nt
    s_waitcnt vmcnt(4)
    buffer_load_dwordx4 v[196:199], v22, s[24:27], s60 offen offset:1024 nt
    s_waitcnt vmcnt(4)
    buffer_load_dwordx4 v[200:203], v22, s[24:27], s60 offen offset:2048 nt
    s_waitcnt vmcnt(4)
    buffer_load_dwordx4 v[204:207], v22, s[24:27], s60 offen offset:3072 nt
    s_or_b32 s60, s60, 0x13000
    s_add_u32 s60, s60, 0x4000
    s_and_b32 s60, s60, 0xecfff
    s_waitcnt vmcnt(4)
    buffer_load_dwordx4 v[208:211], v22, s[24:27], s60 offen nt
    s_waitcnt vmcnt(4)
    buffer_load_dwordx4 v[212:215], v22, s[24:27], s60 offen offset:1024 nt
    s_waitcnt vmcnt(4)
    buffer_load_dwordx4 v[216:219], v22, s[24:27], s60 offen offset:2048 nt
    s_waitcnt vmcnt(4)
    buffer_load_dwordx4 v[220:223], v22, s[24:27], s60 offen offset:3072 nt
    s_or_b32 s60, s60, 0x13000
    s_add_u32 s60, s60, 0x4000
    s_and_b32 s60, s60, 0xecfff
    s_waitcnt vmcnt(4)
    buffer_load_dwordx4 v[224:227], v22, s[24:27], s60 offen nt
    s_waitcnt vmcnt(4)
    buffer_load_dwordx4 v[228:231], v22, s[24:27], s60 offen offset:1024 nt
    s_waitcnt vmcnt(4)
    buffer_load_dwordx4 v[232:235], v22, s[24:27], s60 offen offset:2048 nt
    s_waitcnt vmcnt(4)
    buffer_load_dwordx4 v[236:239], v22, s[24:27], s60 offen offset:3072 nt
    s_or_b32 s60, s60, 0x13000
    s_add_u32 s60, s60, 0x4000
    s_and_b32 s60, s60, 0xecfff
    s_waitcnt vmcnt(4)
    buffer_load_dwordx4 v[240:243], v22, s[24:27], s60 offen nt
    s_waitcnt vmcnt(4)
    buffer_load_dwordx4 v[244:247], v22, s[24:27], s60 offen offset:1024 nt
    s_mov_b32 s70, 0
L_w1:
    ds_read_b32 v19, v24 offset:4224
    s_add_u32 s70, s70, 1
    s_waitcnt lgkmcnt(0)
    v_readfirstlane_b32 s3, v19
    s_cmp_ge_u32 s70, 0x100000
    s_cbranch_scc1 L_w1_ok
    s_cmp_ge_u32 s3, 1
    s_cbranch_scc0 L_w1
L_w1_ok:
    v_lshlrev_b32 v17, 5, v3
    ds_read_b128 v[32:35], v17 offset:15360
    ds_read_b128 v[36:39], v17 offset:15376
    s_waitcnt vmcnt(4)
    buffer_load_dwordx4 v[248:251], v22, s[24:27], s60 offen offset:2048 nt
    s_waitcnt vmcnt(4)
    buffer_load_dwordx4 v[252:255], v22, s[24:27], s60 offen offset:3072 nt
    s_or_b32 s60, s60, 0x13000
    s_add_u32 s60, s60, 0x4000
    s_and_b32 s60, s60, 0xecfff
    s_waitcnt lgkmcnt(0)
    v_cvt_pk_bf16_f32 v28, v32, v33
    v_cvt_pk_bf16_f32 v29, v34, v35
    v_cvt_pk_bf16_f32 v30, v36, v37
    v_cvt_pk_bf16_f32 v31, v38, v39
    v_dot2_f32_bf16 v48, v64, v28, 0
    v_dot2_f32_bf16 v48, v65, v29, v48
    v_dot2_f32_bf16 v48, v66, v30, v48
    v_dot2_f32_bf16 v48, v67, v31, v48
    s_waitcnt vmcnt(4)
    buffer_load_dwordx4 v[64:67], v22, s[24:27], s60 offen nt
    v_dot2_f32_bf16 v49, v68, v28, 0
    v_dot2_f32_bf16 v49, v69, v29, v49
    v_dot2_f32_bf16 v49, v70, v30, v49
    v_dot2_f32_bf16 v49, v71, v31, v49
    v_dot2_f32_bf16 v50, v72, v28, 0
    v_dot2_f32_bf16 v50, v73, v29, v50
    v_dot2_f32_bf16 v50, v74, v30, v50
    v_dot2_f32_bf16 v50, v75, v31, v50
    v_add_f32_dpp v52, v48, v48 row_ror:8 row_mask:0xf bank_mask:0x3
    v_add_f32_dpp v52, v49, v49 row_ror:8 row_mask:0xf bank_mask:0xc
    s_waitcnt vmcnt(4)
    buffer_load_dwordx4 v[68:71], v22, s[24:27], s60 offen offset:1024 nt
    v_dot2_f32_bf16 v51, v76, v28, 0
    v_dot2_f32_bf16 v51, v77, v29, v51
    v_dot2_f32_bf16 v51, v78, v30, v51
    v_dot2_f32_bf16 v51, v79, v31, v51
    v_dot2_f32_bf16 v48, v80, v28, 0
    v_dot2_f32_bf16 v48, v81, v29, v48
    v_dot2_f32_bf16 v48, v82, v30, v48
    v_dot2_f32_bf16 v48, v83, v31, v48
    v_add_f32_dpp v53, v50, v50 row_ror:8 row_mask:0xf bank_mask:0x3
    v_add_f32_dpp v53, v51, v51 row_ror:8 row_mask:0xf bank_mask:0xc
    v_dot2_f32_bf16 v49, v84, v28, 0
    v_dot2_f32_bf16 v49, v85, v29, v49
    v_dot2_f32_bf16 v49, v86, v30, v49
    v_dot2_f32_bf16 v49, v87, v31, v49
    v_add_f32_dpp v54, v52, v52 row_half_mirror row_mask:0xf bank_mask:0x5
    v_add_f32_dpp v54, v53, v53 row_half_mirror row_mask:0xf bank_mask:0xa
    s_waitcnt vmcnt(4)
    buffer_load_dwordx4 v[72:75], v22, s[24:27], s60 offen offset:2048 nt
    v_dot2_f32_bf16 v50, v88, v28, 0
    v_dot2_f32_bf16 v50, v89, v29, v50
    v_dot2_f32_bf16 v50, v90, v30, v50
    v_dot2_f32_bf16 v50, v91, v31, v50
    v_add_f32_dpp v52, v48, v48 row_ror:8 row_mask:0xf bank_mask:0x3
    v_add_f32_dpp v52, v49, v49 row_ror:8 row_mask:0xf bank_mask:0xc
    v_dot2_f32_bf16 v51, v92, v28, 0
    v_dot2_f32_bf16 v51, v93, v29, v51
    v_dot2_f32_bf16 v51, v94, v30, v51
    v_dot2_f32_bf16 v51, v95, v31, v51
    s_waitcnt vmcnt(4)
    buffer_load_dwordx4 v[76:79], v22, s[24:27], s60 offen offset:3072 nt
    s_or_b32 s60, s60, 0x13000
    s_add_u32 s60, s60, 0x4000
    s_and_b32 s60, s60, 0xecfff
    v_dot2_f32_bf16 v48, v96, v28, 0
    v_dot2_f32_bf16 v48, v97, v29, v48
    v_dot2_f32_bf16 v48, v98, v30, v48
    v_dot2_f32_bf16 v48, v99, v31, v48
    v_add_f32_dpp v53, v50, v50 row_ror:8 row_mask:0xf bank_mask:0x3
    v_add_f32_dpp v53, v51, v51 row_ror:8 row_mask:0xf bank_mask:0xc
    v_dot2_f32_bf16 v49, v100, v28, 0
    v_dot2_f32_bf16 v49, v101, v29, v49
    v_dot2_f32_bf16 v49, v102, v30, v49
    v_dot2_f32_bf16 v49, v103, v31, v49
    v_add_f32_dpp v55, v52, v52 row_half_mirror row_mask:0xf bank_mask:0x5
    v_add_f32_dpp v55, v53, v53 row_half_mirror row_mask:0xf bank_mask:0xa
    v_dot2_f32_bf16 v50, v104, v28, 0
    v_dot2_f32_bf16 v50, v105, v29, v50
    v_dot2_f32_bf16 v50, v106, v30, v50
    v_dot2_f32_bf16 v50, v107, v31, v50
    v_add_f32_dpp v58, v54, v54 quad_perm:[2,3,0,1] row_mask:0xf bank_mask:0xf
    v_add_f32_dpp v59, v55, v55 quad_perm:[2,3,0,1] row_mask:0xf bank_mask:0xf
    v_cndmask_b32_e64 v56, v58, v59, s[64:65]
    s_waitcnt vmcnt(4)
    buffer_load_dwordx4 v[80:83], v22, s[24:27], s60 offen nt
    v_dot2_f32_bf16 v51, v108, v28, 0
    v_dot2_f32_bf16 v51, v109, v29, v51
    v_dot2_f32_bf16 v51, v110, v30, v51
    v_dot2_f32_bf16 v51, v111, v31, v51
    v_add_f32_dpp v52, v48, v48 row_ror:8 row_mask:0xf bank_mask:0x3
    v_add_f32_dpp v52, v49, v49 row_ror:8 row_mask:0xf bank_mask:0xc
    v_dot2_f32_bf16 v48, v112, v28, 0
    v_dot2_f32_bf16 v48, v113, v29, v48
    v_dot2_f32_bf16 v48, v114, v30, v48
    v_dot2_f32_bf16 v48, v115, v31, v48
    v_add_f32_dpp v53, v50, v50 row_ror:8 row_mask:0xf bank_mask:0x3
    v_add_f32_dpp v53, v51, v51 row_ror:8 row_mask:0xf bank_mask:0xc
    v_dot2_f32_bf16 v49, v116, v28, 0
    v_dot2_f32_bf16 v49, v117, v29, v49
    v_dot2_f32_bf16 v49, v118, v30, v49
    v_dot2_f32_bf16 v49, v119, v31, v49
    v_add_f32_dpp v54, v52, v52 row_half_mirror row_mask:0xf bank_mask:0x5
    v_add_f32_dpp v54, v53, v53 row_half_mirror row_mask:0xf bank_mask:0xa
    s_waitcnt vmcnt(4)
    buffer_load_dwordx4 v[84:87], v22, s[24:27], s60 offen offset:1024 nt
    v_dot2_f32_bf16 v50, v120, v28, 0
    v_dot2_f32_bf16 v50, v121, v29, v50
    v_dot2_f32_bf16 v50, v122, v30, v50
    v_dot2_f32_bf16 v50, v123, v31, v50
    v_add_f32_dpp v52, v48, v48 row_ror:8 row_mask:0xf bank_mask:0x3
    v_add_f32_dpp v52, v49, v49 row_ror:8 row_mask:0xf bank_mask:0xc
    v_dot2_f32_bf16 v51, v124, v28, 0
    v_dot2_f32_bf16 v51, v125, v29, v51
    v_dot2_f32_bf16 v51, v126, v30, v51
    v_dot2_f32_bf16 v51, v127, v31, v51
    s_waitcnt vmcnt(4)
    buffer_load_dwordx4 v[88:91], v22, s[24:27], s60 offen offset:2048 nt
    v_dot2_f32_bf16 v48, v128, v28, 0
    v_dot2_f32_bf16 v48, v129, v29, v48
    v_dot2_f32_bf16 v48, v130, v30, v48
    v_dot2_f32_bf16 v48, v131, v31, v48
    v_add_f32_dpp v53, v50, v50 row_ror:8 row_mask:0xf bank_mask:0x3
    v_add_f32_dpp v53, v51, v51 row_ror:8 row_mask:0xf bank_mask:0xc
    v_dot2_f32_bf16 v49, v132, v28, 0
    v_dot2_f32_bf16 v49, v133, v29, v49
    v_dot2_f32_bf16 v49, v134, v30, v49
    v_dot2_f32_bf16 v49, v135, v31, v49
    v_add_f32_dpp v55, v52, v52 row_half_mirror row_mask:0xf bank_mask:0x5
    v_add_f32_dpp v55, v53, v53 row_half_mirror row_mask:0xf bank_mask:0xa
    v_dot2_f32_bf16 v50, v136, v28, 0
    v_dot2_f32_bf16 v50, v137, v29, v50
    v_dot2_f32_bf16 v50, v138, v30, v50
    v_dot2_f32_bf16 v50, v139, v31, v50
    v_add_f32_dpp v58, v54, v54 quad_perm:[2,3,0,1] row_mask:0xf bank_mask:0xf
    v_add_f32_dpp v59, v55, v55 quad_perm:[2,3,0,1] row_mask:0xf bank_mask:0xf
    v_cndmask_b32_e64 v57, v58, v59, s[64:65]
    s_waitcnt vmcnt(4)
    buffer_load_dwordx4 v[92:95], v22, s[24:27], s60 offen offset:3072 nt
    s_or_b32 s60, s60, 0x13000
    s_add_u32 s60, s60, 0x4000
    s_and_b32 s60, s60, 0xecfff
    v_dot2_f32_bf16 v51, v140, v28, 0
    v_dot2_f32_bf16 v51, v141, v29, v51
    v_dot2_f32_bf16 v51, v142, v30, v51
    v_dot2_f32_bf16 v51, v143, v31, v51
    v_add_f32_dpp v52, v48, v48 row_ror:8 row_mask:0xf bank_mask:0x3
    v_add_f32_dpp v52, v49, v49 row_ror:8 row_mask:0xf bank_mask:0xc
    v_dot2_f32_bf16 v48, v144, v28, 0
    v_dot2_f32_bf16 v48, v145, v29, v48
    v_dot2_f32_bf16 v48, v146, v30, v48
    v_dot2_f32_bf16 v48, v147, v31, v48
    v_add_f32_dpp v58, v56, v56 quad_perm:[1,0,3,2] row_mask:0xf bank_mask:0xf
    v_add_f32_dpp v59, v57, v57 quad_perm:[1,0,3,2] row_mask:0xf bank_mask:0xf
    v_mov_b32 v32, v33
    v_mov_b32 v33, v34
    v_mov_b32 v34, v35
    v_mov_b32 v35, v36
    v_mov_b32 v36, v37
    v_mov_b32 v37, v38
    v_mov_b32 v38, v39
    v_cndmask_b32_e64 v39, v58, v59, s[66:67]
    v_dot2_f32_bf16 v49, v148, v28, 0
    v_dot2_f32_bf16 v49, v149, v29, v49
    v_dot2_f32_bf16 v49, v150, v30, v49
    v_dot2_f32_bf16 v49, v151, v31, v49
    v_add_f32_dpp v53, v50, v50 row_ror:8 row_mask:0xf bank_mask:0x3
    v_add_f32_dpp v53, v51, v51 row_ror:8 row_mask:0xf bank_mask:0xc
    s_waitcnt vmcnt(4)
    buffer_load_dwordx4 v[96:99], v22, s[24:27], s60 offen nt
    v_dot2_f32_bf16 v50, v152, v28, 0
    v_dot2_f32_bf16 v50, v153, v29, v50
    v_dot2_f32_bf16 v50, v154, v30, v50
    v_dot2_f32_bf16 v50, v155, v31, v50
    v_add_f32_dpp v54, v52, v52 row_half_mirror row_mask:0xf bank_mask:0x5
    v_add_f32_dpp v54, v53, v53 row_half_mirror row_mask:0xf bank_mask:0xa
    v_dot2_f32_bf16 v51, v156, v28, 0
    v_dot2_f32_bf16 v51, v157, v29, v51
    v_dot2_f32_bf16 v51, v158, v30, v51
    v_dot2_f32_bf16 v51, v159, v31, v51
    v_add_f32_dpp v52, v48, v48 row_ror:8 row_mask:0xf bank_mask:0x3
    v_add_f32_dpp v52, v49, v49 row_ror:8 row_mask:0xf bank_mask:0xc
    s_waitcnt vmcnt(4)
    buffer_load_dwordx4 v[100:103], v22, s[24:27], s60 offen offset:1024 nt
    v_dot2_f32_bf16 v48, v160, v28, 0
    v_dot2_f32_bf16 v48, v161, v29, v48
    v_dot2_f32_bf16 v48, v162, v30, v48
    v_dot2_f32_bf16 v48, v163, v31, v48
    v_add_f32_dpp v53, v50, v50 row_ror:8 row_mask:0xf bank_mask:0x3
    v_add_f32_dpp v53, v51, v51 row_ror:8 row_mask:0xf bank_mask:0xc
    v_dot2_f32_bf16 v49, v164, v28, 0
    v_dot2_f32_bf16 v49, v165, v29, v49
    v_dot2_f32_bf16 v49, v166, v30, v49
    v_dot2_f32_bf16 v49, v167, v31, v49
    v_add_f32_dpp v55, v52, v52 row_half_mirror row_mask:0xf bank_mask:0x5
    v_add_f32_dpp v55, v53, v53 row_half_mirror row_mask:0xf bank_mask:0xa
    v_dot2_f32_bf16 v50, v168, v28, 0
    v_dot2_f32_bf16 v50, v169, v29, v50
    v_dot2_f32_bf16 v50, v170, v30, v50
    v_dot2_f32_bf16 v50, v171, v31, v50
    v_add_f32_dpp v58, v54, v54 quad_perm:[2,3,0,1] row_mask:0xf bank_mask:0xf
    v_add_f32_dpp v59, v55, v55 quad_perm:[2,3,0,1] row_mask:0xf bank_mask:0xf
    v_cndmask_b32_e64 v56, v58, v59, s[64:65]
    s_waitcnt vmcnt(4)
    buffer_load_dwordx4 v[104:107], v22, s[24:27], s60 offen offset:2048 nt
    v_dot2_f32_bf16 v51, v172, v28, 0
    v_dot2_f32_bf16 v51, v173, v29, v51
    v_dot2_f32_bf16 v51, v174, v30, v51
    v_dot2_f32_bf16 v51, v175, v31, v51
    v_add_f32_dpp v52, v48, v48 row_ror:8 row_mask:0xf bank_mask:0x3
    v_add_f32_dpp v52, v49, v49 row_ror:8 row_mask:0xf bank_mask:0xc
    v_dot2_f32_bf16 v48, v176, v28, 0
    v_dot2_f32_bf16 v48, v177, v29, v48
    v_dot2_f32_bf16 v48, v178, v30, v48
    v_dot2_f32_bf16 v48, v179, v31, v48
    v_add_f32_dpp v53, v50, v50 row_ror:8 row_mask:0xf bank_mask:0x3
    v_add_f32_dpp v53, v51, v51 row_ror:8 row_mask:0xf bank_mask:0xc
    v_dot2_f32_bf16 v49, v180, v28, 0
    v_dot2_f32_bf16 v49, v181, v29, v49
    v_dot2_f32_bf16 v49, v182, v30, v49
    v_dot2_f32_bf16 v49, v183, v31, v49
    v_add_f32_dpp v54, v52, v52 row_half_mirror row_mask:0xf bank_mask:0x5
    v_add_f32_dpp v54, v53, v53 row_half_mirror row_mask:0xf bank_mask:0xa
    s_waitcnt vmcnt(4)
    buffer_load_dwordx4 v[108:111], v22, s[24:27], s60 offen offset:3072 nt
    s_or_b32 s60, s60, 0x13000
    s_add_u32 s60, s60, 0x4000
    s_and_b32 s60, s60, 0xecfff
    v_dot2_f32_bf16 v50, v184, v28, 0
    v_dot2_f32_bf16 v50, v185, v29, v50
    v_dot2_f32_bf16 v50, v186, v30, v50
    v_dot2_f32_bf16 v50, v187, v31, v50
    v_add_f32_dpp v52, v48, v48 row_ror:8 row_mask:0xf bank_mask:0x3
    v_add_f32_dpp v52, v49, v49 row_ror:8 row_mask:0xf bank_mask:0xc
    v_dot2_f32_bf16 v51, v188, v28, 0
    v_dot2_f32_bf16 v51, v189, v29, v51
    v_dot2_f32_bf16 v51, v190, v30, v51
    v_dot2_f32_bf16 v51, v191, v31, v51
    s_waitcnt vmcnt(4)
    buffer_load_dwordx4 v[112:115], v22, s[24:27], s60 offen nt
    v_dot2_f32_bf16 v48, v192, v28, 0
    v_dot2_f32_bf16 v48, v193, v29, v48
    v_dot2_f32_bf16 v48, v194, v30, v48
    v_dot2_f32_bf16 v48, v195, v31, v48
    v_add_f32_dpp v53, v50, v50 row_ror:8 row_mask:0xf bank_mask:0x3
    v_add_f32_dpp v53, v51, v51 row_ror:8 row_mask:0xf bank_mask:0xc
    v_dot2_f32_bf16 v49, v196, v28, 0
    v_dot2_f32_bf16 v49, v197, v29, v49
    v_dot2_f32_bf16 v49, v198, v30, v49
    v_dot2_f32_bf16 v49, v199, v31, v49
    v_add_f32_dpp v55, v52, v52 row_half_mirror row_mask:0xf bank_mask:0x5
    v_add_f32_dpp v55, v53, v53 row_half_mirror row_mask:0xf bank_mask:0xa
    v_dot2_f32_bf16 v50, v200, v28, 0
    v_dot2_f32_bf16 v50, v201, v29, v50
    v_dot2_f32_bf16 v50, v202, v30, v50
    v_dot2_f32_bf16 v50, v203, v31, v50
    v_add_f32_dpp v58, v54, v54 quad_perm:[2,3,0,1] row_mask:0xf bank_mask:0xf
    v_add_f32_dpp v59, v55, v55 quad_perm:[2,3,0,1] row_mask:0xf bank_mask:0xf
    v_cndmask_b32_e64 v57, v58, v59, s[64:65]
    s_waitcnt vmcnt(4)
    buffer_load_dwordx4 v[116:119], v22, s[24:27], s60 offen offset:1024 nt
    v_dot2_f32_bf16 v51, v204, v28, 0
    v_dot2_f32_bf16 v51, v205, v29, v51
    v_dot2_f32_bf16 v51, v206, v30, v51
    v_dot2_f32_bf16 v51, v207, v31, v51
    v_add_f32_dpp v52, v48, v48 row_ror:8 row_mask:0xf bank_mask:0x3
    v_add_f32_dpp v52, v49, v49 row_ror:8 row_mask:0xf bank_mask:0xc
    v_dot2_f32_bf16 v48, v208, v28, 0
    v_dot2_f32_bf16 v48, v209, v29, v48
    v_dot2_f32_bf16 v48, v210, v30, v48
    v_dot2_f32_bf16 v48, v211, v31, v48
    v_add_f32_dpp v58, v56, v56 quad_perm:[1,0,3,2] row_mask:0xf bank_mask:0xf
    v_add_f32_dpp v59, v57, v57 quad_perm:[1,0,3,2] row_mask:0xf bank_mask:0xf
    v_mov_b32 v32, v33
    v_mov_b32 v33, v34
    v_mov_b32 v34, v35
    v_mov_b32 v35, v36
    v_mov_b32 v36, v37
    v_mov_b32 v37, v38
    v_mov_b32 v38, v39
    v_cndmask_b32_e64 v39, v58, v59, s[66:67]
    v_dot2_f32_bf16 v49, v212, v28, 0
    v_dot2_f32_bf16 v49, v213, v29, v49
    v_dot2_f32_bf16 v49, v214, v30, v49
    v_dot2_f32_bf16 v49, v215, v31, v49
    v_add_f32_dpp v53, v50, v50 row_ror:8 row_mask:0xf bank_mask:0x3
    v_add_f32_dpp v53, v51, v51 row_ror:8 row_mask:0xf bank_mask:0xc
    s_waitcnt vmcnt(4)
    buffer_load_dwordx4 v[120:123], v22, s[24:27], s60 offen offset:2048 nt
    v_dot2_f32_bf16 v50, v216, v28, 0
    v_dot2_f32_bf16 v50, v217, v29, v50
    v_dot2_f32_bf16 v50, v218, v30, v50
    v_dot2_f32_bf16 v50, v219, v31, v50
    v_add_f32_dpp v54, v52, v52 row_half_mirror row_mask:0xf bank_mask:0x5
    v_add_f32_dpp v54, v53, v53 row_half_mirror row_mask:0xf bank_mask:0xa
    v_dot2_f32_bf16 v51, v220, v28, 0
    v_dot2_f32_bf16 v51, v221, v29, v51
    v_dot2_f32_bf16 v51, v222, v30, v51
    v_dot2_f32_bf16 v51, v223, v31, v51
    v_add_f32_dpp v52, v48, v48 row_ror:8 row_mask:0xf bank_mask:0x3
    v_add_f32_dpp v52, v49, v49 row_ror:8 row_mask:0xf bank_mask:0xc
    s_waitcnt vmcnt(4)
    buffer_load_dwordx4 v[124:127], v22, s[24:27], s60 offen offset:3072 nt
    s_or_b32 s60, s60, 0x13000
    s_add_u32 s60, s60, 0x4000
    s_and_b32 s60, s60, 0xecfff
    v_dot2_f32_bf16 v48, v224, v28, 0
    v_dot2_f32_bf16 v48, v225, v29, v48
    v_dot2_f32_bf16 v48, v226, v30, v48
    v_dot2_f32_bf16 v48, v227, v31, v48
    v_add_f32_dpp v53, v50, v50 row_ror:8 row_mask:0xf bank_mask:0x3
    v_add_f32_dpp v53, v51, v51 row_ror:8 row_mask:0xf bank_mask:0xc
    v_dot2_f32_bf16 v49, v228, v28, 0
    v_dot2_f32_bf16 v49, v229, v29, v49
    v_dot2_f32_bf16 v49, v230, v30, v49
    v_dot2_f32_bf16 v49, v231, v31, v49
    v_add_f32_dpp v55, v52, v52 row_half_mirror row_mask:0xf bank_mask:0x5
    v_add_f32_dpp v55, v53, v53 row_half_mirror row_mask:0xf bank_mask:0xa
    v_dot2_f32_bf16 v50, v232, v28, 0
    v_dot2_f32_bf16 v50, v233, v29, v50
    v_dot2_f32_bf16 v50, v234, v30, v50
    v_dot2_f32_bf16 v50, v235, v31, v50
    v_add_f32_dpp v58, v54, v54 quad_perm:[2,3,0,1] row_mask:0xf bank_mask:0xf
    v_add_f32_dpp v59, v55, v55 quad_perm:[2,3,0,1] row_mask:0xf bank_mask:0xf
    v_cndmask_b32_e64 v56, v58, v59, s[64:65]
    s_waitcnt vmcnt(4)
    buffer_load_dwordx4 v[128:131], v22, s[24:27], s60 offen nt
    v_dot2_f32_bf16 v51, v236, v28, 0
    v_dot2_f32_bf16 v51, v237, v29, v51
    v_dot2_f32_bf16 v51, v238, v30, v51
    v_dot2_f32_bf16 v51, v239, v31, v51
    v_add_f32_dpp v52, v48, v48 row_ror:8 row_mask:0xf bank_mask:0x3
    v_add_f32_dpp v52, v49, v49 row_ror:8 row_mask:0xf bank_mask:0xc
    v_dot2_f32_bf16 v48, v240, v28, 0
    v_dot2_f32_bf16 v48, v241, v29, v48
    v_dot2_f32_bf16 v48, v242, v30, v48
    v_dot2_f32_bf16 v48, v243, v31, v48
    v_add_f32_dpp v53, v50, v50 row_ror:8 row_mask:0xf bank_mask:0x3
    v_add_f32_dpp v53, v51, v51 row_ror:8 row_mask:0xf bank_mask:0xc
    v_dot2_f32_bf16 v49, v244, v28, 0
    v_dot2_f32_bf16 v49, v245, v29, v49
    v_dot2_f32_bf16 v49, v246, v30, v49
    v_dot2_f32_bf16 v49, v247, v31, v49
    v_add_f32_dpp v54, v52, v52 row_half_mirror row_mask:0xf bank_mask:0x5
    v_add_f32_dpp v54, v53, v53 row_half_mirror row_mask:0xf bank_mask:0xa
    s_waitcnt vmcnt(4)
    buffer_load_dwordx4 v[132:135], v22, s[24:27], s60 offen offset:1024 nt
    v_dot2_f32_bf16 v50, v248, v28, 0
    v_dot2_f32_bf16 v50, v249, v29, v50
    v_dot2_f32_bf16 v50, v250, v30, v50
    v_dot2_f32_bf16 v50, v251, v31, v50
    v_add_f32_dpp v52, v48, v48 row_ror:8 row_mask:0xf bank_mask:0x3
    v_add_f32_dpp v52, v49, v49 row_ror:8 row_mask:0xf bank_mask:0xc
    v_dot2_f32_bf16 v51, v252, v28, 0
    v_dot2_f32_bf16 v51, v253, v29, v51
    v_dot2_f32_bf16 v51, v254, v30, v51
    v_dot2_f32_bf16 v51, v255, v31, v51
    s_waitcnt vmcnt(4)
    buffer_load_dwordx4 v[136:139], v22, s[24:27], s60 offen offset:2048 nt
    v_dot2_f32_bf16 v48, v64, v28, 0
    v_dot2_f32_bf16 v48, v65, v29, v48
    v_dot2_f32_bf16 v48, v66, v30, v48
    v_dot2_f32_bf16 v48, v67, v31, v48
    v_add_f32_dpp v53, v50, v50 row_ror:8 row_mask:0xf bank_mask:0x3
    v_add_f32_dpp v53, v51, v51 row_ror:8 row_mask:0xf bank_mask:0xc
    v_dot2_f32_bf16 v49, v68, v28, 0
    v_dot2_f32_bf16 v49, v69, v29, v49
    v_dot2_f32_bf16 v49, v70, v30, v49
    v_dot2_f32_bf16 v49, v71, v31, v49
    v_add_f32_dpp v55, v52, v52 row_half_mirror row_mask:0xf bank_mask:0x5
    v_add_f32_dpp v55, v53, v53 row_half_mirror row_mask:0xf bank_mask:0xa
    v_dot2_f32_bf16 v50, v72, v28, 0
    v_dot2_f32_bf16 v50, v73, v29, v50
    v_dot2_f32_bf16 v50, v74, v30, v50
    v_dot2_f32_bf16 v50, v75, v31, v50
    v_add_f32_dpp v58, v54, v54 quad_perm:[2,3,0,1] row_mask:0xf bank_mask:0xf
    v_add_f32_dpp v59, v55, v55 quad_perm:[2,3,0,1] row_mask:0xf bank_mask:0xf
    v_cndmask_b32_e64 v57, v58, v59, s[64:65]
    s_waitcnt vmcnt(4)
    buffer_load_dwordx4 v[140:143], v22, s[24:27], s60 offen offset:3072 nt
    s_or_b32 s60, s60, 0x13000
    s_add_u32 s60, s60, 0x4000
    s_and_b32 s60, s60, 0xecfff
    s_add_u32 s63, s63, 1
    s_cmp_lg_u32 s63, s40
    s_cselect_b64 s[24:25], s[24:25], s[28:29]
    s_cselect_b64 s[28:29], s[28:29], s[30:31]
    s_cselect_b64 s[30:31], s[30:31], s[36:37]
    s_cselect_b64 s[36:37], s[36:37], s[42:43]
    s_cselect_b32 s3, 0, s41
    s_cselect_b32 s41, s41, 32
    s_add_u32 s40, s40, s3
    v_dot2_f32_bf16 v51, v76, v28, 0
    v_dot2_f32_bf16 v51, v77, v29, v51
    v_dot2_f32_bf16 v51, v78, v30, v51
    v_dot2_f32_bf16 v51, v79, v31, v51
    v_add_f32_dpp v52, v48, v48 row_ror:8 row_mask:0xf bank_mask:0x3
    v_add_f32_dpp v52, v49, v49 row_ror:8 row_mask:0xf bank_mask:0xc
    v_dot2_f32_bf16 v48, v80, v28, 0
    v_dot2_f32_bf16 v48, v81, v29, v48
    v_dot2_f32_bf16 v48, v82, v30, v48
    v_dot2_f32_bf16 v48, v83, v31, v48
    v_add_f32_dpp v58, v56, v56 quad_perm:[1,0,3,2] row_mask:0xf bank_mask:0xf
    v_add_f32_dpp v59, v57, v57 quad_perm:[1,0,3,2] row_mask:0xf bank_mask:0xf
    v_mov_b32 v32, v33
    v_mov_b32 v33, v34
    v_mov_b32 v34, v35
    v_mov_b32 v35, v36
    v_mov_b32 v36, v37
    v_mov_b32 v37, v38
    v_mov_b32 v38, v39
    v_cndmask_b32_e64 v39, v58, v59, s[66:67]
    v_dot2_f32_bf16 v49, v84, v28, 0
    v_dot2_f32_bf16 v49, v85, v29, v49
    v_dot2_f32_bf16 v49, v86, v30, v49
    v_dot2_f32_bf16 v49, v87, v31, v49
    v_add_f32_dpp v53, v50, v50 row_ror:8 row_mask:0xf bank_mask:0x3
    v_add_f32_dpp v53, v51, v51 row_ror:8 row_mask:0xf bank_mask:0xc
    s_waitcnt vmcnt(4)
    buffer_load_dwordx4 v[144:147], v22, s[24:27], s60 offen nt
    v_dot2_f32_bf16 v50, v88, v28, 0
    v_dot2_f32_bf16 v50, v89, v29, v50
    v_dot2_f32_bf16 v50, v90, v30, v50
    v_dot2_f32_bf16 v50, v91, v31, v50
    v_add_f32_dpp v54, v52, v52 row_half_mirror row_mask:0xf bank_mask:0x5
    v_add_f32_dpp v54, v53, v53 row_half_mirror row_mask:0xf bank_mask:0xa
    v_dot2_f32_bf16 v51, v92, v28, 0
    v_dot2_f32_bf16 v51, v93, v29, v51
    v_dot2_f32_bf16 v51, v94, v30, v51
    v_dot2_f32_bf16 v51, v95, v31, v51
    v_add_f32_dpp v52, v48, v48 row_ror:8 row_mask:0xf bank_mask:0x3
    v_add_f32_dpp v52, v49, v49 row_ror:8 row_mask:0xf bank_mask:0xc
    s_waitcnt vmcnt(4)
    buffer_load_dwordx4 v[148:151], v22, s[24:27], s60 offen offset:1024 nt
    v_dot2_f32_bf16 v48, v96, v28, 0
    v_dot2_f32_bf16 v48, v97, v29, v48
    v_dot2_f32_bf16 v48, v98, v30, v48
    v_dot2_f32_bf16 v48, v99, v31, v48
    v_add_f32_dpp v53, v50, v50 row_ror:8 row_mask:0xf bank_mask:0x3
    v_add_f32_dpp v53, v51, v51 row_ror:8 row_mask:0xf bank_mask:0xc
    v_dot2_f32_bf16 v49, v100, v28, 0
    v_dot2_f32_bf16 v49, v101, v29, v49
    v_dot2_f32_bf16 v49, v102, v30, v49
    v_dot2_f32_bf16 v49, v103, v31, v49
    v_add_f32_dpp v55, v52, v52 row_half_mirror row_mask:0xf bank_mask:0x5
    v_add_f32_dpp v55, v53, v53 row_half_mirror row_mask:0xf bank_mask:0xa
    v_dot2_f32_bf16 v50, v104, v28, 0
    v_dot2_f32_bf16 v50, v105, v29, v50
    v_dot2_f32_bf16 v50, v106, v30, v50
    v_dot2_f32_bf16 v50, v107, v31, v50
    v_add_f32_dpp v58, v54, v54 quad_perm:[2,3,0,1] row_mask:0xf bank_mask:0xf
    v_add_f32_dpp v59, v55, v55 quad_perm:[2,3,0,1] row_mask:0xf bank_mask:0xf
    v_cndmask_b32_e64 v56, v58, v59, s[64:65]
    s_waitcnt vmcnt(4)
    buffer_load_dwordx4 v[152:155], v22, s[24:27], s60 offen offset:2048 nt
    v_dot2_f32_bf16 v51, v108, v28, 0
    v_dot2_f32_bf16 v51, v109, v29, v51
    v_dot2_f32_bf16 v51, v110, v30, v51
    v_dot2_f32_bf16 v51, v111, v31, v51
    v_add_f32_dpp v52, v48, v48 row_ror:8 row_mask:0xf bank_mask:0x3
    v_add_f32_dpp v52, v49, v49 row_ror:8 row_mask:0xf bank_mask:0xc
    v_dot2_f32_bf16 v48, v112, v28, 0
    v_dot2_f32_bf16 v48, v113, v29, v48
    v_dot2_f32_bf16 v48, v114, v30, v48
    v_dot2_f32_bf16 v48, v115, v31, v48
    v_add_f32_dpp v53, v50, v50 row_ror:8 row_mask:0xf bank_mask:0x3
    v_add_f32_dpp v53, v51, v51 row_ror:8 row_mask:0xf bank_mask:0xc
    v_dot2_f32_bf16 v49, v116, v28, 0
    v_dot2_f32_bf16 v49, v117, v29, v49
    v_dot2_f32_bf16 v49, v118, v30, v49
    v_dot2_f32_bf16 v49, v119, v31, v49
    v_add_f32_dpp v54, v52, v52 row_half_mirror row_mask:0xf bank_mask:0x5
    v_add_f32_dpp v54, v53, v53 row_half_mirror row_mask:0xf bank_mask:0xa
    s_waitcnt vmcnt(4)
    buffer_load_dwordx4 v[156:159], v22, s[24:27], s60 offen offset:3072 nt
    s_or_b32 s60, s60, 0x13000
    s_add_u32 s60, s60, 0x4000
    s_and_b32 s60, s60, 0xecfff
    s_add_u32 s63, s63, 1
    s_cmp_lg_u32 s63, s40
    s_cselect_b64 s[24:25], s[24:25], s[28:29]
    s_cselect_b64 s[28:29], s[28:29], s[30:31]
    s_cselect_b64 s[30:31], s[30:31], s[36:37]
    s_cselect_b64 s[36:37], s[36:37], s[42:43]
    s_cselect_b32 s3, 0, s41
    s_cselect_b32 s41, s41, 32
    s_add_u32 s40, s40, s3
    v_dot2_f32_bf16 v50, v120, v28, 0
    v_dot2_f32_bf16 v50, v121, v29, v50
    v_dot2_f32_bf16 v50, v122, v30, v50
    v_dot2_f32_bf16 v50, v123, v31, v50
    v_add_f32_dpp v52, v48, v48 row_ror:8 row_mask:0xf bank_mask:0x3
    v_add_f32_dpp v52, v49, v49 row_ror:8 row_mask:0xf bank_mask:0xc
    v_dot2_f32_bf16 v51, v124, v28, 0
    v_dot2_f32_bf16 v51, v125, v29, v51
    v_dot2_f32_bf16 v51, v126, v30, v51
    v_dot2_f32_bf16 v51, v127, v31, v51
    s_lshl_b32 s3, s56, 2
    v_mov_b32 v25, s3
    v_mov_b32 v70, 0
    s_mul_i32 s39, s59, -2
    s_add_u32 s39, s39, 64
    s_lshl_b32 s75, s56, 30
    s_mov_b32 s73, 4
L_kA:
    s_waitcnt lgkmcnt(0)
    s_add_u32 s39, s39, 4
    v_readfirstlane_b32 s74, v70
    v_mov_b32 v71, s39
    ds_write_b32 v25, v71 offset:4256
    ds_read_b32 v70, v25 offset:4272
    s_waitcnt vmcnt(5)
    s_add_u32 s75, s75, s74
    s_cbranch_scc1 L_f2
    s_waitcnt vmcnt(4)
L_f2:
    buffer_load_dwordx4 v[160:163], v22, s[24:27], s60 offen nt
    v_dot2_f32_bf16 v48, v128, v28, 0
    v_dot2_f32_bf16 v48, v129, v29, v48
    v_dot2_f32_bf16 v48, v130, v30, v48
    v_dot2_f32_bf16 v48, v131, v31, v48
    v_add_f32_dpp v53, v50, v50 row_ror:8 row_mask:0xf bank_mask:0x3
    v_add_f32_dpp v53, v51, v51 row_ror:8 row_mask:0xf bank_mask:0xc
    s_waitcnt vmcnt(5)
    s_add_u32 s75, s75, s74
    s_cbranch_scc1 L_f3
    s_waitcnt vmcnt(4)
L_f3:
    buffer_load_dwordx4 v[164:167], v22, s[24:27], s60 offen offset:1024 nt
    v_dot2_f32_bf16 v49, v132, v28, 0
    v_dot2_f32_bf16 v49, v133, v29, v49
    v_dot2_f32_bf16 v49, v134, v30, v49
    v_dot2_f32_bf16 v49, v135, v31, v49
    v_add_f32_dpp v55, v52, v52 row_half_mirror row_mask:0xf bank_mask:0x5
    v_add_f32_dpp v55, v53, v53 row_half_mirror row_mask:0xf bank_mask:0xa
    s_waitcnt vmcnt(5)
    s_add_u32 s75, s75, s74
    s_cbranch_scc1 L_f4
    s_waitcnt vmcnt(4)
L_f4:
    buffer_load_dwordx4 v[168:171], v22, s[24:27], s60 offen offset:2048 nt
    v_dot2_f32_bf16 v50, v136, v28, 0
    v_dot2_f32_bf16 v50, v137, v29, v50
    v_dot2_f32_bf16 v50, v138, v30, v50
    v_dot2_f32_bf16 v50, v139, v31, v50
    v_add_f32_dpp v58, v54, v54 quad_perm:[2,3,0,1] row_mask:0xf bank_mask:0xf
    v_add_f32_dpp v59, v55, v55 quad_perm:[2,3,0,1] row_mask:0xf bank_mask:0xf
    v_cndmask_b32_e64 v57, v58, v59, s[64:65]
    s_waitcnt vmcnt(5)
    s_add_u32 s75, s75, s74
    s_cbranch_scc1 L_f5
    s_waitcnt vmcnt(4)
L_f5:
    buffer_load_dwordx4 v[172:175], v22, s[24:27], s60 offen offset:3072 nt
    s_or_b32 s60, s60, 0x13000
    s_add_u32 s60, s60, 0x4000
    s_and_b32 s60, s60, 0xecfff
    s_add_u32 s63, s63, 1
    s_cmp_lg_u32 s63, s40
    s_cselect_b64 s[24:25], s[24:25], s[28:29]
    s_cselect_b64 s[28:29], s[28:29], s[30:31]
    s_cselect_b64 s[30:31], s[30:31], s[36:37]
    s_cselect_b64 s[36:37], s[36:37], s[42:43]
    s_cselect_b32 s3, 0, s41
    s_cselect_b32 s41, s41, 32
    s_add_u32 s40, s40, s3
    v_dot2_f32_bf16 v51, v140, v28, 0
    v_dot2_f32_bf16 v51, v141, v29, v51
    v_dot2_f32_bf16 v51, v142, v30, v51
    v_dot2_f32_bf16 v51, v143, v31, v51
    v_add_f32_dpp v52, v48, v48 row_ror:8 row_mask:0xf bank_mask:0x3
    v_add_f32_dpp v52, v49, v49 row_ror:8 row_mask:0xf bank_mask:0xc
    s_waitcnt lgkmcnt(0)
    s_add_u32 s39, s39, 4
    v_readfirstlane_b32 s74, v70
    v_mov_b32 v71, s39
    ds_write_b32 v25, v71 offset:4256
    ds_read_b32 v70, v25 offset:4272
    s_waitcnt vmcnt(5)
    s_add_u32 s75, s75, s74
    s_cbranch_scc1 L_f6
    s_waitcnt vmcnt(4)
L_f6:
    buffer_load_dwordx4 v[176:179], v22, s[24:27], s60 offen nt
    v_dot2_f32_bf16 v48, v144, v28, 0
    v_dot2_f32_bf16 v48, v145, v29, v48
    v_dot2_f32_bf16 v48, v146, v30, v48
    v_dot2_f32_bf16 v48, v147, v31, v48
    v_add_f32_dpp v58, v56, v56 quad_perm:[1,0,3,2] row_mask:0xf bank_mask:0xf
    v_add_f32_dpp v59, v57, v57 quad_perm:[1,0,3,2] row_mask:0xf bank_mask:0xf
    v_mov_b32 v32, v33
    v_mov_b32 v33, v34
    v_mov_b32 v34, v35
    v_mov_b32 v35, v36
    v_mov_b32 v36, v37
    v_mov_b32 v37, v38
    v_mov_b32 v38, v39
    v_cndmask_b32_e64 v39, v58, v59, s[66:67]
    s_waitcnt vmcnt(5)
    s_add_u32 s75, s75, s74
    s_cbranch_scc1 L_f7
    s_waitcnt vmcnt(4)
L_f7:
    buffer_load_dwordx4 v[180:183], v22, s[24:27], s60 offen offset:1024 nt
    v_dot2_f32_bf16 v49, v148, v28, 0
    v_dot2_f32_bf16 v49, v149, v29, v49
    v_dot2_f32_bf16 v49, v150, v30, v49
    v_dot2_f32_bf16 v49, v151, v31, v49
    v_add_f32_dpp v53, v50, v50 row_ror:8 row_mask:0xf bank_mask:0x3
    v_add_f32_dpp v53, v51, v51 row_ror:8 row_mask:0xf bank_mask:0xc
    s_waitcnt vmcnt(5)
    s_add_u32 s75, s75, s74
    s_cbranch_scc1 L_f8
    s_waitcnt vmcnt(4)
L_f8:
    buffer_load_dwordx4 v[184:187], v22, s[24:27], s60 offen offset:2048 nt
    v_dot2_f32_bf16 v50, v152, v28, 0
    v_dot2_f32_bf16 v50, v153, v29, v50
    v_dot2_f32_bf16 v50, v154, v30, v50
    v_dot2_f32_bf16 v50, v155, v31, v50
    v_add_f32_dpp v54, v52, v52 row_half_mirror row_mask:0xf bank_mask:0x5
    v_add_f32_dpp v54, v53, v53 row_half_mirror row_mask:0xf bank_mask:0xa
    s_waitcnt vmcnt(5)
    s_add_u32 s75, s75, s74
    s_cbranch_scc1 L_f9
    s_waitcnt vmcnt(4)
L_f9:
    buffer_load_dwordx4 v[188:191], v22, s[24:27], s60 offen offset:3072 nt
    s_or_b32 s60, s60, 0x13000
    s_add_u32 s60, s60, 0x4000
    s_and_b32 s60, s60, 0xecfff
    s_add_u32 s63, s63, 1
    s_cmp_lg_u32 s63, s40
    s_cselect_b64 s[24:25], s[24:25], s[28:29]
    s_cselect_b64 s[28:29], s[28:29], s[30:31]
    s_cselect_b64 s[30:31], s[30:31], s[36:37]
    s_cselect_b64 s[36:37], s[36:37], s[42:43]
    s_cselect_b32 s3, 0, s41
    s_cselect_b32 s41, s41, 32
    s_add_u32 s40, s40, s3
    v_dot2_f32_bf16 v51, v156, v28, 0
    v_dot2_f32_bf16 v51, v157, v29, v51
    v_dot2_f32_bf16 v51, v158, v30, v51
    v_dot2_f32_bf16 v51, v159, v31, v51
    v_add_f32_dpp v52, v48, v48 row_ror:8 row_mask:0xf bank_mask:0x3
    v_add_f32_dpp v52, v49, v49 row_ror:8 row_mask:0xf bank_mask:0xc
    s_waitcnt lgkmcnt(0)
    s_add_u32 s39, s39, 4
    v_readfirstlane_b32 s74, v70
    v_mov_b32 v71, s39
    ds_write_b32 v25, v71 offset:4256
    ds_read_b32 v70, v25 offset:4272
    s_waitcnt vmcnt(5)
    s_add_u32 s75, s75, s74
    s_cbranch_scc1 L_f10
    s_waitcnt vmcnt(4)
L_f10:
    buffer_load_dwordx4 v[128:131], v22, s[24:27], s60 offen nt
    v_dot2_f32_bf16 v48, v160, v28, 0
    v_dot2_f32_bf16 v48, v161, v29, v48
    v_dot2_f32_bf16 v48, v162, v30, v48
    v_dot2_f32_bf16 v48, v163, v31, v48
    v_add_f32_dpp v53, v50, v50 row_ror:8 row_mask:0xf bank_mask:0x3
    v_add_f32_dpp v53, v51, v51 row_ror:8 row_mask:0xf bank_mask:0xc
    s_waitcnt vmcnt(5)
    s_add_u32 s75, s75, s74
    s_cbranch_scc1 L_f11
    s_waitcnt vmcnt(4)
L_f11:
    buffer_load_dwordx4 v[132:135], v22, s[24:27], s60 offen offset:1024 nt
    v_dot2_f32_bf16 v49, v164, v28, 0
    v_dot2_f32_bf16 v49, v165, v29, v49
    v_dot2_f32_bf16 v49, v166, v30, v49
    v_dot2_f32_bf16 v49, v167, v31, v49
    v_add_f32_dpp v55, v52, v52 row_half_mirror row_mask:0xf bank_mask:0x5
    v_add_f32_dpp v55, v53, v53 row_half_mirror row_mask:0xf bank_mask:0xa
    s_waitcnt vmcnt(5)
    s_add_u32 s75, s75, s74
    s_cbranch_scc1 L_f12
    s_waitcnt vmcnt(4)
L_f12:
    buffer_load_dwordx4 v[136:139], v22, s[24:27], s60 offen offset:2048 nt
    v_dot2_f32_bf16 v50, v168, v28, 0
    v_dot2_f32_bf16 v50, v169, v29, v50
    v_dot2_f32_bf16 v50, v170, v30, v50
    v_dot2_f32_bf16 v50, v171, v31, v50
    v_add_f32_dpp v58, v54, v54 quad_perm:[2,3,0,1] row_mask:0xf bank_mask:0xf
    v_add_f32_dpp v59, v55, v55 quad_perm:[2,3,0,1] row_mask:0xf bank_mask:0xf
    v_cndmask_b32_e64 v56, v58, v59, s[64:65]
    s_waitcnt vmcnt(5)
    s_add_u32 s75, s75, s74
    s_cbranch_scc1 L_f13
    s_waitcnt vmcnt(4)
L_f13:
    buffer_load_dwordx4 v[140:143], v22, s[24:27], s60 offen offset:3072 nt
    s_or_b32 s60, s60, 0x13000
    s_add_u32 s60, s60, 0x4000
    s_and_b32 s60, s60, 0xecfff
    s_add_u32 s63, s63, 1
    s_cmp_lg_u32 s63, s40
    s_cselect_b64 s[24:25], s[24:25], s[28:29]
    s_cselect_b64 s[28:29], s[28:29], s[30:31]
    s_cselect_b64 s[30:31], s[30:31], s[36:37]
    s_cselect_b64 s[36:37], s[36:37], s[42:43]
    s_cselect_b32 s3, 0, s41
    s_cselect_b32 s41, s41, 32
    s_add_u32 s40, s40, s3
    v_dot2_f32_bf16 v51, v172, v28, 0
    v_dot2_f32_bf16 v51, v173, v29, v51
    v_dot2_f32_bf16 v51, v174, v30, v51
    v_dot2_f32_bf16 v51, v175, v31, v51
    v_add_f32_dpp v52, v48, v48 row_ror:8 row_mask:0xf bank_mask:0x3
    v_add_f32_dpp v52, v49, v49 row_ror:8 row_mask:0xf bank_mask:0xc
    s_waitcnt lgkmcnt(0)
    s_add_u32 s39, s39, 4
    v_readfirstlane_b32 s74, v70
    v_mov_b32 v71, s39
    ds_write_b32 v25, v71 offset:4256
    ds_read_b32 v70, v25 offset:4272
    s_waitcnt vmcnt(5)
    s_add_u32 s75, s75, s74
    s_cbranch_scc1 L_f14
    s_waitcnt vmcnt(4)
L_f14:
    buffer_load_dwordx4 v[144:147], v22, s[24:27], s60 offen nt
    v_dot2_f32_bf16 v48, v176, v28, 0
    v_dot2_f32_bf16 v48, v177, v29, v48
    v_dot2_f32_bf16 v48, v178, v30, v48
    v_dot2_f32_bf16 v48, v179, v31, v48
    v_add_f32_dpp v53, v50, v50 row_ror:8 row_mask:0xf bank_mask:0x3
    v_add_f32_dpp v53, v51, v51 row_ror:8 row_mask:0xf bank_mask:0xc
    s_waitcnt vmcnt(5)
    s_add_u32 s75, s75, s74
    s_cbranch_scc1 L_f15
    s_waitcnt vmcnt(4)
L_f15:
    buffer_load_dwordx4 v[148:151], v22, s[24:27], s60 offen offset:1024 nt
    v_dot2_f32_bf16 v49, v180, v28, 0
    v_dot2_f32_bf16 v49, v181, v29, v49
    v_dot2_f32_bf16 v49, v182, v30, v49
    v_dot2_f32_bf16 v49, v183, v31, v49
    v_add_f32_dpp v54, v52, v52 row_half_mirror row_mask:0xf bank_mask:0x5
    v_add_f32_dpp v54, v53, v53 row_half_mirror row_mask:0xf bank_mask:0xa
    s_waitcnt vmcnt(5)
    s_add_u32 s75, s75, s74
    s_cbranch_scc1 L_f16
    s_waitcnt vmcnt(4)
L_f16:
    buffer_load_dwordx4 v[152:155], v22, s[24:27], s60 offen offset:2048 nt
    v_dot2_f32_bf16 v50, v184, v28, 0
    v_dot2_f32_bf16 v50, v185, v29, v50
    v_dot2_f32_bf16 v50, v186, v30, v50
    v_dot2_f32_bf16 v50, v187, v31, v50
    v_add_f32_dpp v52, v48, v48 row_ror:8 row_mask:0xf bank_mask:0x3
    v_add_f32_dpp v52, v49, v49 row_ror:8 row_mask:0xf bank_mask:0xc
    s_waitcnt vmcnt(5)
    s_add_u32 s75, s75, s74
    s_cbranch_scc1 L_f17
    s_waitcnt vmcnt(4)
L_f17:
    buffer_load_dwordx4 v[156:159], v22, s[24:27], s60 offen offset:3072 nt
    s_or_b32 s60, s60, 0x13000
    s_add_u32 s60, s60, 0x4000
    s_and_b32 s60, s60, 0xecfff
    s_add_u32 s63, s63, 1
    s_cmp_lg_u32 s63, s40
    s_cselect_b64 s[24:25], s[24:25], s[28:29]
    s_cselect_b64 s[28:29], s[28:29], s[30:31]
    s_cselect_b64 s[30:31], s[30:31], s[36:37]
    s_cselect_b64 s[36:37], s[36:37], s[42:43]
    s_cselect_b32 s3, 0, s41
    s_cselect_b32 s41, s41, 32
    s_add_u32 s40, s40, s3
    v_dot2_f32_bf16 v51, v188, v28, 0
    v_dot2_f32_bf16 v51, v189, v29, v51
    v_dot2_f32_bf16 v51, v190, v30, v51
    v_dot2_f32_bf16 v51, v191, v31, v51
    s_sub_u32 s73, s73, 1
    s_cmp_lg_u32 s73, 0
    s_nop 0
    s_cbranch_scc1 L_kA
    s_waitcnt vmcnt(4)
    buffer_load_dwordx4 v[160:163], v22, s[24:27], s60 offen nt
    v_add_f32_dpp v53, v50, v50 row_ror:8 row_mask:0xf bank_mask:0x3
    v_add_f32_dpp v53, v51, v51 row_ror:8 row_mask:0xf bank_mask:0xc
    v_add_f32_dpp v55, v52, v52 row_half_mirror row_mask:0xf bank_mask:0x5
    s_nop 0
    v_add_f32_dpp v55, v53, v53 row_half_mirror row_mask:0xf bank_mask:0xa
    v_add_f32_dpp v58, v54, v54 quad_perm:[2,3,0,1] row_mask:0xf bank_mask:0xf
    s_nop 0
    v_add_f32_dpp v59, v55, v55 quad_perm:[2,3,0,1] row_mask:0xf bank_mask:0xf
    v_cndmask_b32_e64 v57, v58, v59, s[64:65]
    v_add_f32_dpp v58, v56, v56 quad_perm:[1,0,3,2] row_mask:0xf bank_mask:0xf
    s_nop 0
    v_add_f32_dpp v59, v57, v57 quad_perm:[1,0,3,2] row_mask:0xf bank_mask:0xf
    v_mov_b32 v32, v33
    v_mov_b32 v33, v34
    v_mov_b32 v34, v35
    v_mov_b32 v35, v36
    v_mov_b32 v36, v37
    v_mov_b32 v37, v38
    v_mov_b32 v38, v39
    v_cndmask_b32_e64 v39, v58, v59, s[66:67]
    v_max3_f32 v17, v32, v33, v34
    v_max3_f32 v17, v17, v35, v36
    v_max3_f32 v17, v17, v37, v38
    v_max_f32 v17, v17, v39
    s_nop 1
    v_max_f32_dpp v17, v17, v17 row_ror:8 row_mask:0xf bank_mask:0xf
    s_nop 1
    v_max_f32_dpp v17, v17, v17 row_ror:4 row_mask:0xf bank_mask:0xf
    s_nop 1
    v_max_f32_dpp v17, v17, v17 row_ror:2 row_mask:0xf bank_mask:0xf
    s_nop 1
    v_max_f32_dpp v17, v17, v17 row_ror:1 row_mask:0xf bank_mask:0xf
    s_nop 1
    v_max_f32_dpp v17, v17, v17 row_bcast:15 row_mask:0xa bank_mask:0xf
    s_nop 1
    v_max_f32_dpp v17, v17, v17 row_bcast:31 row_mask:0xc bank_mask:0xf
    s_nop 0
    v_readlane_b32 s68, v17, 63
    s_waitcnt vmcnt(4)
    buffer_load_dwordx4 v[164:167], v22, s[24:27], s60 offen offset:1024 nt
    v_mov_b32 v20, s68
    v_mul_f32 v20, s72, v20
    v_fma_f32 v32, v32, s72, -v20
    v_fma_f32 v33, v33, s72, -v20
    v_fma_f32 v34, v34, s72, -v20
    v_fma_f32 v35, v35, s72, -v20
    v_fma_f32 v36, v36, s72, -v20
    v_fma_f32 v37, v37, s72, -v20
    v_fma_f32 v38, v38, s72, -v20
    v_fma_f32 v39, v39, s72, -v20
    v_exp_f32 v32, v32
    v_exp_f32 v33, v33
    v_exp_f32 v34, v34
    v_exp_f32 v35, v35
    v_exp_f32 v36, v36
    v_exp_f32 v37, v37
    v_exp_f32 v38, v38
    v_exp_f32 v39, v39
    s_waitcnt vmcnt(4)
    buffer_load_dwordx4 v[168:171], v22, s[24:27], s60 offen offset:2048 nt
    v_add_f32 v17, v32, v33
    v_add_f32 v17, v17, v34
    v_add_f32 v17, v17, v35
    v_add_f32 v17, v17, v36
    v_add_f32 v17, v17, v37
    v_add_f32 v17, v17, v38
    v_add_f32 v17, v17, v39
    v_cvt_pk_bf16_f32 v32, v32, v32
    v_cvt_pk_bf16_f32 v33, v33, v33
    v_cvt_pk_bf16_f32 v34, v34, v34
    v_cvt_pk_bf16_f32 v35, v35, v35
    v_cvt_pk_bf16_f32 v36, v36, v36
    v_cvt_pk_bf16_f32 v37, v37, v37
    v_cvt_pk_bf16_f32 v38, v38, v38
    v_cvt_pk_bf16_f32 v39, v39, v39
    v_add_f32_dpp v17, v17, v17 row_ror:8 row_mask:0xf bank_mask:0xf
    s_nop 1
    v_add_f32_dpp v17, v17, v17 row_ror:4 row_mask:0xf bank_mask:0xf
    s_nop 1
    v_add_f32_dpp v17, v17, v17 row_ror:2 row_mask:0xf bank_mask:0xf
    s_nop 1
    v_add_f32_dpp v17, v17, v17 row_ror:1 row_mask:0xf bank_mask:0xf
    s_nop 1
    v_add_f32_dpp v17, v17, v17 row_bcast:15 row_mask:0xa bank_mask:0xf
    s_nop 1
    v_add_f32_dpp v17, v17, v17 row_bcast:31 row_mask:0xc bank_mask:0xf
    s_nop 0
    v_readlane_b32 s69, v17, 63
    s_waitcnt vmcnt(4)
    buffer_load_dwordx4 v[172:175], v22, s[24:27], s60 offen offset:3072 nt
    s_or_b32 s60, s60, 0x13000
    s_add_u32 s60, s60, 0x4000
    s_and_b32 s60, s60, 0xecfff
    s_add_u32 s63, s63, 1
    s_cmp_lg_u32 s63, s40
    s_cselect_b64 s[24:25], s[24:25], s[28:29]
    s_cselect_b64 s[28:29], s[28:29], s[30:31]
    s_cselect_b64 s[30:31], s[30:31], s[36:37]
    s_cselect_b64 s[36:37], s[36:37], s[42:43]
    s_cselect_b32 s3, 0, s41
    s_cselect_b32 s41, s41, 32
    s_add_u32 s40, s40, s3
    v_mov_b32 v21, s69
    s_lshl_b32 s3, s56, 3
    v_mov_b32 v17, s3
    s_mov_b64 exec, 1
    ds_write_b64 v17, v[20:21] offset:4096
    s_mov_b64 exec, -1
    v_mov_b32 v60, 0
    v_mov_b32 v61, 0
    v_mov_b32 v62, 0
    v_mov_b32 v63, 0
    v_and_b32_dpp v8, v32, v4 row_newbcast:0 row_mask:0xf bank_mask:0xf
    v_and_b32_dpp v9, v32, v5 row_newbcast:0 row_mask:0xf bank_mask:0xf
    v_and_b32_dpp v10, v32, v6 row_newbcast:0 row_mask:0xf bank_mask:0xf
    v_and_b32_dpp v11, v32, v7 row_newbcast:0 row_mask:0xf bank_mask:0xf
    s_mov_b32 s73, 6
    s_nop 0
L_vA:
    s_waitcnt lgkmcnt(0)
    s_add_u32 s39, s39, 4
    v_readfirstlane_b32 s74, v70
    v_mov_b32 v71, s39
    ds_write_b32 v25, v71 offset:4256
    ds_read_b32 v70, v25 offset:4272
    s_waitcnt vmcnt(5)
    s_add_u32 s75, s75, s74
    s_cbranch_scc1 L_f18
    s_waitcnt vmcnt(4)
L_f18:
    buffer_load_dwordx4 v[176:179], v22, s[24:27], s60 offen nt
    v_mfma_f32_16x16x32_bf16 v[60:63], v[8:11], v[128:131], v[60:63]
    v_and_b32_dpp v12, v32, v4 row_newbcast:8 row_mask:0xf bank_mask:0xf
    v_and_b32_dpp v13, v32, v5 row_newbcast:8 row_mask:0xf bank_mask:0xf
    v_and_b32_dpp v14, v32, v6 row_newbcast:8 row_mask:0xf bank_mask:0xf
    v_and_b32_dpp v15, v32, v7 row_newbcast:8 row_mask:0xf bank_mask:0xf
    s_waitcnt vmcnt(5)
    s_add_u32 s75, s75, s74
    s_cbranch_scc1 L_f19
    s_waitcnt vmcnt(4)
L_f19:
    buffer_load_dwordx4 v[180:183], v22, s[24:27], s60 offen offset:1024 nt
    v_mfma_f32_16x16x32_bf16 v[60:63], v[12:15], v[132:135], v[60:63]
    v_and_b32_dpp v8, v32, v4 row_newbcast:4 row_mask:0xf bank_mask:0xf
    v_and_b32_dpp v9, v32, v5 row_newbcast:4 row_mask:0xf bank_mask:0xf
    v_and_b32_dpp v10, v32, v6 row_newbcast:4 row_mask:0xf bank_mask:0xf
    v_and_b32_dpp v11, v32, v7 row_newbcast:4 row_mask:0xf bank_mask:0xf
    s_waitcnt vmcnt(5)
    s_add_u32 s75, s75, s74
    s_cbranch_scc1 L_f20
    s_waitcnt vmcnt(4)
L_f20:
    buffer_load_dwordx4 v[184:187], v22, s[24:27], s60 offen offset:2048 nt
    v_mfma_f32_16x16x32_bf16 v[60:63], v[8:11], v[136:139], v[60:63]
    v_and_b32_dpp v12, v32, v4 row_newbcast:12 row_mask:0xf bank_mask:0xf
    v_and_b32_dpp v13, v32, v5 row_newbcast:12 row_mask:0xf bank_mask:0xf
    v_and_b32_dpp v14, v32, v6 row_newbcast:12 row_mask:0xf bank_mask:0xf
    v_and_b32_dpp v15, v32, v7 row_newbcast:12 row_mask:0xf bank_mask:0xf
    s_waitcnt vmcnt(5)
    s_add_u32 s75, s75, s74
    s_cbranch_scc1 L_f21
    s_waitcnt vmcnt(4)
L_f21:
    buffer_load_dwordx4 v[188:191], v22, s[24:27], s60 offen offset:3072 nt
    s_or_b32 s60, s60, 0x13000
    s_add_u32 s60, s60, 0x4000
    s_and_b32 s60, s60, 0xecfff
    s_add_u32 s63, s63, 1
    s_cmp_lg_u32 s63, s40
    s_cselect_b64 s[24:25], s[24:25], s[28:29]
    s_cselect_b64 s[28:29], s[28:29], s[30:31]
    s_cselect_b64 s[30:31], s[30:31], s[36:37]
    s_cselect_b64 s[36:37], s[36:37], s[42:43]
    s_cselect_b32 s3, 0, s41
    s_cselect_b32 s41, s41, 32
    s_add_u32 s40, s40, s3
    v_mfma_f32_16x16x32_bf16 v[60:63], v[12:15], v[140:143], v[60:63]
    v_and_b32_dpp v8, v32, v4 row_newbcast:2 row_mask:0xf bank_mask:0xf
    v_and_b32_dpp v9, v32, v5 row_newbcast:2 row_mask:0xf bank_mask:0xf
    v_and_b32_dpp v10, v32, v6 row_newbcast:2 row_mask:0xf bank_mask:0xf
    v_and_b32_dpp v11, v32, v7 row_newbcast:2 row_mask:0xf bank_mask:0xf
    s_waitcnt lgkmcnt(0)
    s_add_u32 s39, s39, 4
    v_readfirstlane_b32 s74, v70
    v_mov_b32 v71, s39
    ds_write_b32 v25, v71 offset:4256
    ds_read_b32 v70, v25 offset:4272
    s_waitcnt vmcnt(5)
    s_add_u32 s75, s75, s74
    s_cbranch_scc1 L_f22
    s_waitcnt vmcnt(4)
L_f22:
    buffer_load_dwordx4 v[128:131], v22, s[24:27], s60 offen nt
    v_mfma_f32_16x16x32_bf16 v[60:63], v[8:11], v[144:147], v[60:63]
    v_and_b32_dpp v12, v32, v4 row_newbcast:10 row_mask:0xf bank_mask:0xf
    v_and_b32_dpp v13, v32, v5 row_newbcast:10 row_mask:0xf bank_mask:0xf
    v_and_b32_dpp v14, v32, v6 row_newbcast:10 row_mask:0xf bank_mask:0xf
    v_and_b32_dpp v15, v32, v7 row_newbcast:10 row_mask:0xf bank_mask:0xf
    s_waitcnt vmcnt(5)
    s_add_u32 s75, s75, s74
    s_cbranch_scc1 L_f23
    s_waitcnt vmcnt(4)
L_f23:
    buffer_load_dwordx4 v[132:135], v22, s[24:27], s60 offen offset:1024 nt
    v_mfma_f32_16x16x32_bf16 v[60:63], v[12:15], v[148:151], v[60:63]
    v_and_b32_dpp v8, v32, v4 row_newbcast:6 row_mask:0xf bank_mask:0xf
    v_and_b32_dpp v9, v32, v5 row_newbcast:6 row_mask:0xf bank_mask:0xf
    v_and_b32_dpp v10, v32, v6 row_newbcast:6 row_mask:0xf bank_mask:0xf
    v_and_b32_dpp v11, v32, v7 row_newbcast:6 row_mask:0xf bank_mask:0xf
    s_waitcnt vmcnt(5)
    s_add_u32 s75, s75, s74
    s_cbranch_scc1 L_f24
    s_waitcnt vmcnt(4)
L_f24:
    buffer_load_dwordx4 v[136:139], v22, s[24:27], s60 offen offset:2048 nt
    v_mfma_f32_16x16x32_bf16 v[60:63], v[8:11], v[152:155], v[60:63]
    v_and_b32_dpp v12, v32, v4 row_newbcast:14 row_mask:0xf bank_mask:0xf
    v_and_b32_dpp v13, v32, v5 row_newbcast:14 row_mask:0xf bank_mask:0xf
    v_and_b32_dpp v14, v32, v6 row_newbcast:14 row_mask:0xf bank_mask:0xf
    v_and_b32_dpp v15, v32, v7 row_newbcast:14 row_mask:0xf bank_mask:0xf
    s_waitcnt vmcnt(5)
    s_add_u32 s75, s75, s74
    s_cbranch_scc1 L_f25
    s_waitcnt vmcnt(4)
L_f25:
    buffer_load_dwordx4 v[140:143], v22, s[24:27], s60 offen offset:3072 nt
    s_or_b32 s60, s60, 0x13000
    s_add_u32 s60, s60, 0x4000
    s_and_b32 s60, s60, 0xecfff
    s_add_u32 s63, s63, 1
    s_cmp_lg_u32 s63, s40
    s_cselect_b64 s[24:25], s[24:25], s[28:29]
    s_cselect_b64 s[28:29], s[28:29], s[30:31]
    s_cselect_b64 s[30:31], s[30:31], s[36:37]
    s_cselect_b64 s[36:37], s[36:37], s[42:43]
    s_cselect_b32 s3, 0, s41
    s_cselect_b32 s41, s41, 32
    s_add_u32 s40, s40, s3
    v_mfma_f32_16x16x32_bf16 v[60:63], v[12:15], v[156:159], v[60:63]
    v_and_b32_dpp v8, v32, v4 row_newbcast:1 row_mask:0xf bank_mask:0xf
    v_and_b32_dpp v9, v32, v5 row_newbcast:1 row_mask:0xf bank_mask:0xf
    v_and_b32_dpp v10, v32, v6 row_newbcast:1 row_mask:0xf bank_mask:0xf
    v_and_b32_dpp v11, v32, v7 row_newbcast:1 row_mask:0xf bank_mask:0xf
    s_waitcnt lgkmcnt(0)
    s_add_u32 s39, s39, 4
    v_readfirstlane_b32 s74, v70
    v_mov_b32 v71, s39
    ds_write_b32 v25, v71 offset:4256
    ds_read_b32 v70, v25 offset:4272
    s_waitcnt vmcnt(5)
    s_add_u32 s75, s75, s74
    s_cbranch_scc1 L_f26
    s_waitcnt vmcnt(4)
L_f26:
    buffer_load_dwordx4 v[144:147], v22, s[24:27], s60 offen nt
    v_mfma_f32_16x16x32_bf16 v[60:63], v[8:11], v[160:163], v[60:63]
    v_and_b32_dpp v12, v32, v4 row_newbcast:9 row_mask:0xf bank_mask:0xf
    v_and_b32_dpp v13, v32, v5 row_newbcast:9 row_mask:0xf bank_mask:0xf
    v_and_b32_dpp v14, v32, v6 row_newbcast:9 row_mask:0xf bank_mask:0xf
    v_and_b32_dpp v15, v32, v7 row_newbcast:9 row_mask:0xf bank_mask:0xf
    s_waitcnt vmcnt(5)
    s_add_u32 s75, s75, s74
    s_cbranch_scc1 L_f27
    s_waitcnt vmcnt(4)
L_f27:
    buffer_load_dwordx4 v[148:151], v22, s[24:27], s60 offen offset:1024 nt
    v_mfma_f32_16x16x32_bf16 v[60:63], v[12:15], v[164:167], v[60:63]
    v_and_b32_dpp v8, v32, v4 row_newbcast:5 row_mask:0xf bank_mask:0xf
    v_and_b32_dpp v9, v32, v5 row_newbcast:5 row_mask:0xf bank_mask:0xf
    v_and_b32_dpp v10, v32, v6 row_newbcast:5 row_mask:0xf bank_mask:0xf
    v_and_b32_dpp v11, v32, v7 row_newbcast:5 row_mask:0xf bank_mask:0xf
    s_waitcnt vmcnt(5)
    s_add_u32 s75, s75, s74
    s_cbranch_scc1 L_f28
    s_waitcnt vmcnt(4)
L_f28:
    buffer_load_dwordx4 v[152:155], v22, s[24:27], s60 offen offset:2048 nt
    v_mfma_f32_16x16x32_bf16 v[60:63], v[8:11], v[168:171], v[60:63]
    v_and_b32_dpp v12, v32, v4 row_newbcast:13 row_mask:0xf bank_mask:0xf
    v_and_b32_dpp v13, v32, v5 row_newbcast:13 row_mask:0xf bank_mask:0xf
    v_and_b32_dpp v14, v32, v6 row_newbcast:13 row_mask:0xf bank_mask:0xf
    v_and_b32_dpp v15, v32, v7 row_newbcast:13 row_mask:0xf bank_mask:0xf
    s_waitcnt vmcnt(5)
    s_add_u32 s75, s75, s74
    s_cbranch_scc1 L_f29
    s_waitcnt vmcnt(4)
L_f29:
    buffer_load_dwordx4 v[156:159], v22, s[24:27], s60 offen offset:3072 nt
    s_or_b32 s60, s60, 0x13000
    s_add_u32 s60, s60, 0x4000
    s_and_b32 s60, s60, 0xecfff
    s_add_u32 s63, s63, 1
    s_cmp_lg_u32 s63, s40
    s_cselect_b64 s[24:25], s[24:25], s[28:29]
    s_cselect_b64 s[28:29], s[28:29], s[30:31]
    s_cselect_b64 s[30:31], s[30:31], s[36:37]
    s_cselect_b64 s[36:37], s[36:37], s[42:43]
    s_cselect_b32 s3, 0, s41
    s_cselect_b32 s41, s41, 32
    s_add_u32 s40, s40, s3
    v_mfma_f32_16x16x32_bf16 v[60:63], v[12:15], v[172:175], v[60:63]
    v_and_b32_dpp v8, v32, v4 row_newbcast:3 row_mask:0xf bank_mask:0xf
    v_and_b32_dpp v9, v32, v5 row_newbcast:3 row_mask:0xf bank_mask:0xf
    v_and_b32_dpp v10, v32, v6 row_newbcast:3 row_mask:0xf bank_mask:0xf
    v_and_b32_dpp v11, v32, v7 row_newbcast:3 row_mask:0xf bank_mask:0xf
    s_waitcnt lgkmcnt(0)
    s_add_u32 s39, s39, 4
    v_readfirstlane_b32 s74, v70
    v_mov_b32 v71, s39
    ds_write_b32 v25, v71 offset:4256
    ds_read_b32 v70, v25 offset:4272
    s_waitcnt vmcnt(5)
    s_add_u32 s75, s75, s74
    s_cbranch_scc1 L_f30
    s_waitcnt vmcnt(4)
L_f30:
    buffer_load_dwordx4 v[160:163], v22, s[24:27], s60 offen nt
    v_mfma_f32_16x16x32_bf16 v[60:63], v[8:11], v[176:179], v[60:63]
    v_and_b32_dpp v12, v32, v4 row_newbcast:11 row_mask:0xf bank_mask:0xf
    v_and_b32_dpp v13, v32, v5 row_newbcast:11 row_mask:0xf bank_mask:0xf
    v_and_b32_dpp v14, v32, v6 row_newbcast:11 row_mask:0xf bank_mask:0xf
    v_and_b32_dpp v15, v32, v7 row_newbcast:11 row_mask:0xf bank_mask:0xf
    s_waitcnt vmcnt(5)
    s_add_u32 s75, s75, s74
    s_cbranch_scc1 L_f31
    s_waitcnt vmcnt(4)
L_f31:
    buffer_load_dwordx4 v[164:167], v22, s[24:27], s60 offen offset:1024 nt
    v_mfma_f32_16x16x32_bf16 v[60:63], v[12:15], v[180:183], v[60:63]
    v_and_b32_dpp v8, v32, v4 row_newbcast:7 row_mask:0xf bank_mask:0xf
    v_and_b32_dpp v9, v32, v5 row_newbcast:7 row_mask:0xf bank_mask:0xf
    v_and_b32_dpp v10, v32, v6 row_newbcast:7 row_mask:0xf bank_mask:0xf
    v_and_b32_dpp v11, v32, v7 row_newbcast:7 row_mask:0xf bank_mask:0xf
    s_waitcnt vmcnt(5)
    s_add_u32 s75, s75, s74
    s_cbranch_scc1 L_f32
    s_waitcnt vmcnt(4)
L_f32:
    buffer_load_dwordx4 v[168:171], v22, s[24:27], s60 offen offset:2048 nt
    v_mfma_f32_16x16x32_bf16 v[60:63], v[8:11], v[184:187], v[60:63]
    v_and_b32_dpp v12, v32, v4 row_newbcast:15 row_mask:0xf bank_mask:0xf
    v_and_b32_dpp v13, v32, v5 row_newbcast:15 row_mask:0xf bank_mask:0xf
    v_and_b32_dpp v14, v32, v6 row_newbcast:15 row_mask:0xf bank_mask:0xf
    v_and_b32_dpp v15, v32, v7 row_newbcast:15 row_mask:0xf bank_mask:0xf
    s_waitcnt vmcnt(5)
    s_add_u32 s75, s75, s74
    s_cbranch_scc1 L_f33
    s_waitcnt vmcnt(4)
L_f33:
    buffer_load_dwordx4 v[172:175], v22, s[24:27], s60 offen offset:3072 nt
    s_or_b32 s60, s60, 0x13000
    s_add_u32 s60, s60, 0x4000
    s_and_b32 s60, s60, 0xecfff
    s_add_u32 s63, s63, 1
    s_cmp_lg_u32 s63, s40
    s_cselect_b64 s[24:25], s[24:25], s[28:29]
    s_cselect_b64 s[28:29], s[28:29], s[30:31]
    s_cselect_b64 s[30:31], s[30:31], s[36:37]
    s_cselect_b64 s[36:37], s[36:37], s[42:43]
    s_cselect_b32 s3, 0, s41
    s_cselect_b32 s41, s41, 32
    s_add_u32 s40, s40, s3
    v_mfma_f32_16x16x32_bf16 v[60:63], v[12:15], v[188:191], v[60:63]
    v_and_b32_dpp v8, v33, v4 row_newbcast:0 row_mask:0xf bank_mask:0xf
    v_and_b32_dpp v9, v33, v5 row_newbcast:0 row_mask:0xf bank_mask:0xf
    v_and_b32_dpp v10, v33, v6 row_newbcast:0 row_mask:0xf bank_mask:0xf
    v_and_b32_dpp v11, v33, v7 row_newbcast:0 row_mask:0xf bank_mask:0xf
    v_mov_b32 v32, v33
    v_mov_b32 v33, v34
    v_mov_b32 v34, v35
    v_mov_b32 v35, v36
    v_mov_b32 v36, v37
    v_mov_b32 v37, v38
    v_mov_b32 v38, v39
    s_sub_u32 s73, s73, 1
    s_cmp_lg_u32 s73, 0
    s_cbranch_scc1 L_vA
    s_cmp_eq_u32 s59, 0
    s_cbranch_scc1 L_half0
    s_waitcnt lgkmcnt(0)
    s_add_u32 s39, s39, 16
    v_readfirstlane_b32 s74, v70
    v_mov_b32 v71, s39
    ds_write_b32 v25, v71 offset:4256
    ds_read_b32 v70, v25 offset:4272
    s_waitcnt vmcnt(4)
    buffer_load_dwordx4 v[176:179], v22, s[24:27], s60 offen nt
    v_mfma_f32_16x16x32_bf16 v[60:63], v[8:11], v[128:131], v[60:63]
    v_and_b32_dpp v12, v32, v4 row_newbcast:8 row_mask:0xf bank_mask:0xf
    v_and_b32_dpp v13, v32, v5 row_newbcast:8 row_mask:0xf bank_mask:0xf
    v_and_b32_dpp v14, v32, v6 row_newbcast:8 row_mask:0xf bank_mask:0xf
    v_and_b32_dpp v15, v32, v7 row_newbcast:8 row_mask:0xf bank_mask:0xf
    s_waitcnt vmcnt(4)
    buffer_load_dwordx4 v[180:183], v22, s[24:27], s60 offen offset:1024 nt
    v_mfma_f32_16x16x32_bf16 v[60:63], v[12:15], v[132:135], v[60:63]
    v_and_b32_dpp v8, v32, v4 row_newbcast:4 row_mask:0xf bank_mask:0xf
    v_and_b32_dpp v9, v32, v5 row_newbcast:4 row_mask:0xf bank_mask:0xf
    v_and_b32_dpp v10, v32, v6 row_newbcast:4 row_mask:0xf bank_mask:0xf
    v_and_b32_dpp v11, v32, v7 row_newbcast:4 row_mask:0xf bank_mask:0xf
    s_waitcnt vmcnt(4)
    buffer_load_dwordx4 v[184:187], v22, s[24:27], s60 offen offset:2048 nt
    v_mfma_f32_16x16x32_bf16 v[60:63], v[8:11], v[136:139], v[60:63]
    v_and_b32_dpp v12, v32, v4 row_newbcast:12 row_mask:0xf bank_mask:0xf
    v_and_b32_dpp v13, v32, v5 row_newbcast:12 row_mask:0xf bank_mask:0xf
    v_and_b32_dpp v14, v32, v6 row_newbcast:12 row_mask:0xf bank_mask:0xf
    v_and_b32_dpp v15, v32, v7 row_newbcast:12 row_mask:0xf bank_mask:0xf
    s_waitcnt vmcnt(4)
    buffer_load_dwordx4 v[188:191], v22, s[24:27], s60 offen offset:3072 nt
    s_or_b32 s60, s60, 0x13000
    s_add_u32 s60, s60, 0x4000
    s_and_b32 s60, s60, 0xecfff
    s_add_u32 s63, s63, 1
    s_cmp_lg_u32 s63, s40
    s_cselect_b64 s[24:25], s[24:25], s[28:29]
    s_cselect_b64 s[28:29], s[28:29], s[30:31]
    s_cselect_b64 s[30:31], s[30:31], s[36:37]
    s_cselect_b64 s[36:37], s[36:37], s[42:43]
    s_cselect_b32 s3, 0, s41
    s_cselect_b32 s41, s41, 32
    s_add_u32 s40, s40, s3
    v_mfma_f32_16x16x32_bf16 v[60:63], v[12:15], v[140:143], v[60:63]
    v_and_b32_dpp v8, v32, v4 row_newbcast:2 row_mask:0xf bank_mask:0xf
    v_and_b32_dpp v9, v32, v5 row_newbcast:2 row_mask:0xf bank_mask:0xf
    v_and_b32_dpp v10, v32, v6 row_newbcast:2 row_mask:0xf bank_mask:0xf
    v_and_b32_dpp v11, v32, v7 row_newbcast:2 row_mask:0xf bank_mask:0xf
    s_waitcnt vmcnt(4)
    buffer_load_dwordx4 v[128:131], v22, s[24:27], s60 offen nt
    v_mfma_f32_16x16x32_bf16 v[60:63], v[8:11], v[144:147], v[60:63]
    v_and_b32_dpp v12, v32, v4 row_newbcast:10 row_mask:0xf bank_mask:0xf
    v_and_b32_dpp v13, v32, v5 row_newbcast:10 row_mask:0xf bank_mask:0xf
    v_and_b32_dpp v14, v32, v6 row_newbcast:10 row_mask:0xf bank_mask:0xf
    v_and_b32_dpp v15, v32, v7 row_newbcast:10 row_mask:0xf bank_mask:0xf
    s_waitcnt vmcnt(4)
    buffer_load_dwordx4 v[132:135], v22, s[24:27], s60 offen offset:1024 nt
    v_mfma_f32_16x16x32_bf16 v[60:63], v[12:15], v[148:151], v[60:63]
    v_and_b32_dpp v8, v32, v4 row_newbcast:6 row_mask:0xf bank_mask:0xf
    v_and_b32_dpp v9, v32, v5 row_newbcast:6 row_mask:0xf bank_mask:0xf
    v_and_b32_dpp v10, v32, v6 row_newbcast:6 row_mask:0xf bank_mask:0xf
    v_and_b32_dpp v11, v32, v7 row_newbcast:6 row_mask:0xf bank_mask:0xf
    s_waitcnt vmcnt(4)
    buffer_load_dwordx4 v[136:139], v22, s[24:27], s60 offen offset:2048 nt
    v_mfma_f32_16x16x32_bf16 v[60:63], v[8:11], v[152:155], v[60:63]
    v_and_b32_dpp v12, v32, v4 row_newbcast:14 row_mask:0xf bank_mask:0xf
    v_and_b32_dpp v13, v32, v5 row_newbcast:14 row_mask:0xf bank_mask:0xf
    v_and_b32_dpp v14, v32, v6 row_newbcast:14 row_mask:0xf bank_mask:0xf
    v_and_b32_dpp v15, v32, v7 row_newbcast:14 row_mask:0xf bank_mask:0xf
    s_waitcnt vmcnt(4)
    buffer_load_dwordx4 v[140:143], v22, s[24:27], s60 offen offset:3072 nt
    s_or_b32 s60, s60, 0x13000
    s_add_u32 s60, s60, 0x4000
    s_and_b32 s60, s60, 0xecfff
    s_add_u32 s63, s63, 1
    s_cmp_lg_u32 s63, s40
    s_cselect_b64 s[24:25], s[24:25], s[28:29]
    s_cselect_b64 s[28:29], s[28:29], s[30:31]
    s_cselect_b64 s[30:31], s[30:31], s[36:37]
    s_cselect_b64 s[36:37], s[36:37], s[42:43]
    s_cselect_b32 s3, 0, s41
    s_cselect_b32 s41, s41, 32
    s_add_u32 s40, s40, s3
    v_mfma_f32_16x16x32_bf16 v[60:63], v[12:15], v[156:159], v[60:63]
    v_and_b32_dpp v8, v32, v4 row_newbcast:1 row_mask:0xf bank_mask:0xf
    v_and_b32_dpp v9, v32, v5 row_newbcast:1 row_mask:0xf bank_mask:0xf
    v_and_b32_dpp v10, v32, v6 row_newbcast:1 row_mask:0xf bank_mask:0xf
    v_and_b32_dpp v11, v32, v7 row_newbcast:1 row_mask:0xf bank_mask:0xf
    s_waitcnt vmcnt(4)
    buffer_load_dwordx4 v[144:147], v22, s[24:27], s60 offen nt
    v_mfma_f32_16x16x32_bf16 v[60:63], v[8:11], v[160:163], v[60:63]
    v_and_b32_dpp v12, v32, v4 row_newbcast:9 row_mask:0xf bank_mask:0xf
    v_and_b32_dpp v13, v32, v5 row_newbcast:9 row_mask:0xf bank_mask:0xf
    v_and_b32_dpp v14, v32, v6 row_newbcast:9 row_mask:0xf bank_mask:0xf
    v_and_b32_dpp v15, v32, v7 row_newbcast:9 row_mask:0xf bank_mask:0xf
    s_waitcnt vmcnt(4)
    buffer_load_dwordx4 v[148:151], v22, s[24:27], s60 offen offset:1024 nt
    v_mfma_f32_16x16x32_bf16 v[60:63], v[12:15], v[164:167], v[60:63]
    v_and_b32_dpp v8, v32, v4 row_newbcast:5 row_mask:0xf bank_mask:0xf
    v_and_b32_dpp v9, v32, v5 row_newbcast:5 row_mask:0xf bank_mask:0xf
    v_and_b32_dpp v10, v32, v6 row_newbcast:5 row_mask:0xf bank_mask:0xf
    v_and_b32_dpp v11, v32, v7 row_newbcast:5 row_mask:0xf bank_mask:0xf
    s_waitcnt vmcnt(4)
    buffer_load_dwordx4 v[152:155], v22, s[24:27], s60 offen offset:2048 nt
    v_mfma_f32_16x16x32_bf16 v[60:63], v[8:11], v[168:171], v[60:63]
    v_and_b32_dpp v12, v32, v4 row_newbcast:13 row_mask:0xf bank_mask:0xf
    v_and_b32_dpp v13, v32, v5 row_newbcast:13 row_mask:0xf bank_mask:0xf
    v_and_b32_dpp v14, v32, v6 row_newbcast:13 row_mask:0xf bank_mask:0xf
    v_and_b32_dpp v15, v32, v7 row_newbcast:13 row_mask:0xf bank_mask:0xf
    s_waitcnt vmcnt(4)
    buffer_load_dwordx4 v[156:159], v22, s[24:27], s60 offen offset:3072 nt
    s_or_b32 s60, s60, 0x13000
    s_add_u32 s60, s60, 0x4000
    s_and_b32 s60, s60, 0xecfff
    s_add_u32 s63, s63, 1
    s_cmp_lg_u32 s63, s40
    s_cselect_b64 s[24:25], s[24:25], s[28:29]
    s_cselect_b64 s[28:29], s[28:29], s[30:31]
    s_cselect_b64 s[30:31], s[30:31], s[36:37]
    s_cselect_b64 s[36:37], s[36:37], s[42:43]
    s_cselect_b32 s3, 0, s41
    s_cselect_b32 s41, s41, 32
    s_add_u32 s40, s40, s3
    v_mfma_f32_16x16x32_bf16 v[60:63], v[12:15], v[172:175], v[60:63]
    v_and_b32_dpp v8, v32, v4 row_newbcast:3 row_mask:0xf bank_mask:0xf
    v_and_b32_dpp v9, v32, v5 row_newbcast:3 row_mask:0xf bank_mask:0xf
    v_and_b32_dpp v10, v32, v6 row_newbcast:3 row_mask:0xf bank_mask:0xf
    v_and_b32_dpp v11, v32, v7 row_newbcast:3 row_mask:0xf bank_mask:0xf
    s_waitcnt vmcnt(4)
    buffer_load_dwordx4 v[160:163], v22, s[24:27], s60 offen nt
    v_mfma_f32_16x16x32_bf16 v[60:63], v[8:11], v[176:179], v[60:63]
    v_and_b32_dpp v12, v32, v4 row_newbcast:11 row_mask:0xf bank_mask:0xf
    v_and_b32_dpp v13, v32, v5 row_newbcast:11 row_mask:0xf bank_mask:0xf
    v_and_b32_dpp v14, v32, v6 row_newbcast:11 row_mask:0xf bank_mask:0xf
    v_and_b32_dpp v15, v32, v7 row_newbcast:11 row_mask:0xf bank_mask:0xf
    s_waitcnt vmcnt(4)
    buffer_load_dwordx4 v[164:167], v22, s[24:27], s60 offen offset:1024 nt
    v_mfma_f32_16x16x32_bf16 v[60:63], v[12:15], v[180:183], v[60:63]
    v_and_b32_dpp v8, v32, v4 row_newbcast:7 row_mask:0xf bank_mask:0xf
    v_and_b32_dpp v9, v32, v5 row_newbcast:7 row_mask:0xf bank_mask:0xf
    v_and_b32_dpp v10, v32, v6 row_newbcast:7 row_mask:0xf bank_mask:0xf
    v_and_b32_dpp v11, v32, v7 row_newbcast:7 row_mask:0xf bank_mask:0xf
    s_waitcnt vmcnt(4)
    buffer_load_dwordx4 v[168:171], v22, s[24:27], s60 offen offset:2048 nt
    v_mfma_f32_16x16x32_bf16 v[60:63], v[8:11], v[184:187], v[60:63]
    v_and_b32_dpp v12, v32, v4 row_newbcast:15 row_mask:0xf bank_mask:0xf
    v_and_b32_dpp v13, v32, v5 row_newbcast:15 row_mask:0xf bank_mask:0xf
    v_and_b32_dpp v14, v32, v6 row_newbcast:15 row_mask:0xf bank_mask:0xf
    v_and_b32_dpp v15, v32, v7 row_newbcast:15 row_mask:0xf bank_mask:0xf
    s_waitcnt vmcnt(4)
    buffer_load_dwordx4 v[172:175], v22, s[24:27], s60 offen offset:3072 nt
    s_or_b32 s60, s60, 0x13000
    s_add_u32 s60, s60, 0x4000
    s_and_b32 s60, s60, 0xecfff
    s_add_u32 s63, s63, 1
    s_cmp_lg_u32 s63, s40
    s_cselect_b64 s[24:25], s[24:25], s[28:29]
    s_cselect_b64 s[28:29], s[28:29], s[30:31]
    s_cselect_b64 s[30:31], s[30:31], s[36:37]
    s_cselect_b64 s[36:37], s[36:37], s[42:43]
    s_cselect_b32 s3, 0, s41
    s_cselect_b32 s41, s41, 32
    s_add_u32 s40, s40, s3
    v_mfma_f32_16x16x32_bf16 v[60:63], v[12:15], v[188:191], v[60:63]
    v_and_b32_dpp v8, v33, v4 row_newbcast:0 row_mask:0xf bank_mask:0xf
    v_and_b32_dpp v9, v33, v5 row_newbcast:0 row_mask:0xf bank_mask:0xf
    v_and_b32_dpp v10, v33, v6 row_newbcast:0 row_mask:0xf bank_mask:0xf
    v_and_b32_dpp v11, v33, v7 row_newbcast:0 row_mask:0xf bank_mask:0xf
    v_mov_b32 v32, v33
    v_mov_b32 v33, v34
    v_mov_b32 v34, v35
    v_mov_b32 v35, v36
    v_mov_b32 v36, v37
    v_mov_b32 v37, v38
    v_mov_b32 v38, v39
    s_waitcnt vmcnt(4)
    buffer_load_dwordx4 v[176:179], v22, s[24:27], s60 offen nt
    s_mov_b32 s70, 0
L_m34:
    ds_read_b128 v[40:43], v24 offset:4096
    ds_read_b128 v[44:47], v24 offset:4112
    s_add_u32 s70, s70, 1
    s_waitcnt lgkmcnt(0)
    v_min3_u32 v18, v41, v43, v45
    v_min3_u32 v18, v18, v47, v47
    s_cmp_ge_u32 s70, 0x100000
    v_readfirstlane_b32 s3, v18
    s_cbranch_scc1 L_m34_ok
    s_cmp_lg_u32 s3, 0
    s_cbranch_scc0 L_m34
L_m34_ok:
    s_waitcnt vmcnt(4)
    buffer_load_dwordx4 v[180:183], v22, s[24:27], s60 offen offset:1024 nt
    v_max3_f32 v17, v40, v42, v44
    v_max_f32 v17, v17, v46
    v_sub_f32 v20, v20, v17
    v_exp_f32 v20, v20
    s_waitcnt lgkmcnt(0)
    s_add_u32 s39, s39, 16
    v_readfirstlane_b32 s74, v70
    v_mov_b32 v71, s39
    ds_write_b32 v25, v71 offset:4256
    ds_read_b32 v70, v25 offset:4272
    s_waitcnt vmcnt(4)
    buffer_load_dwordx4 v[184:187], v22, s[24:27], s60 offen offset:2048 nt
    v_mfma_f32_16x16x32_bf16 v[60:63], v[8:11], v[128:131], v[60:63]
    v_and_b32_dpp v12, v32, v4 row_newbcast:8 row_mask:0xf bank_mask:0xf
    v_and_b32_dpp v13, v32, v5 row_newbcast:8 row_mask:0xf bank_mask:0xf
    v_and_b32_dpp v14, v32, v6 row_newbcast:8 row_mask:0xf bank_mask:0xf
    v_and_b32_dpp v15, v32, v7 row_newbcast:8 row_mask:0xf bank_mask:0xf
    s_nop 1
    v_mfma_f32_16x16x32_bf16 v[60:63], v[12:15], v[132:135], v[60:63]
    v_and_b32_dpp v8, v32, v4 row_newbcast:4 row_mask:0xf bank_mask:0xf
    v_and_b32_dpp v9, v32, v5 row_newbcast:4 row_mask:0xf bank_mask:0xf
    v_and_b32_dpp v10, v32, v6 row_newbcast:4 row_mask:0xf bank_mask:0xf
    v_and_b32_dpp v11, v32, v7 row_newbcast:4 row_mask:0xf bank_mask:0xf
    s_waitcnt vmcnt(4)
    buffer_load_dwordx4 v[188:191], v22, s[24:27], s60 offen offset:3072 nt
    s_or_b32 s60, s60, 0x13000
    s_add_u32 s60, s60, 0x4000
    s_and_b32 s60, s60, 0xecfff
    s_add_u32 s63, s63, 1
    s_cmp_lg_u32 s63, s40
    s_cselect_b64 s[24:25], s[24:25], s[28:29]
    s_cselect_b64 s[28:29], s[28:29], s[30:31]
    s_cselect_b64 s[30:31], s[30:31], s[36:37]
    s_cselect_b64 s[36:37], s[36:37], s[42:43]
    s_cselect_b32 s3, 0, s41
    s_cselect_b32 s41, s41, 32
    s_add_u32 s40, s40, s3
    v_mfma_f32_16x16x32_bf16 v[60:63], v[8:11], v[136:139], v[60:63]
    v_and_b32_dpp v12, v32, v4 row_newbcast:12 row_mask:0xf bank_mask:0xf
    v_and_b32_dpp v13, v32, v5 row_newbcast:12 row_mask:0xf bank_mask:0xf
    v_and_b32_dpp v14, v32, v6 row_newbcast:12 row_mask:0xf bank_mask:0xf
    v_and_b32_dpp v15, v32, v7 row_newbcast:12 row_mask:0xf bank_mask:0xf
    s_nop 1
    v_mfma_f32_16x16x32_bf16 v[60:63], v[12:15], v[140:143], v[60:63]
    v_and_b32_dpp v8, v32, v4 row_newbcast:2 row_mask:0xf bank_mask:0xf
    v_and_b32_dpp v9, v32, v5 row_newbcast:2 row_mask:0xf bank_mask:0xf
    v_and_b32_dpp v10, v32, v6 row_newbcast:2 row_mask:0xf bank_mask:0xf
    v_and_b32_dpp v11, v32, v7 row_newbcast:2 row_mask:0xf bank_mask:0xf
    s_waitcnt vmcnt(4)
    buffer_load_dwordx4 v[128:131], v22, s[24:27], s60 offen nt
    v_mfma_f32_16x16x32_bf16 v[60:63], v[8:11], v[144:147], v[60:63]
    v_and_b32_dpp v12, v32, v4 row_newbcast:10 row_mask:0xf bank_mask:0xf
    v_and_b32_dpp v13, v32, v5 row_newbcast:10 row_mask:0xf bank_mask:0xf
    v_and_b32_dpp v14, v32, v6 row_newbcast:10 row_mask:0xf bank_mask:0xf
    v_and_b32_dpp v15, v32, v7 row_newbcast:10 row_mask:0xf bank_mask:0xf
    s_nop 1
    v_mfma_f32_16x16x32_bf16 v[60:63], v[12:15], v[148:151], v[60:63]
    v_and_b32_dpp v8, v32, v4 row_newbcast:6 row_mask:0xf bank_mask:0xf
    v_and_b32_dpp v9, v32, v5 row_newbcast:6 row_mask:0xf bank_mask:0xf
    v_and_b32_dpp v10, v32, v6 row_newbcast:6 row_mask:0xf bank_mask:0xf
    v_and_b32_dpp v11, v32, v7 row_newbcast:6 row_mask:0xf bank_mask:0xf
    s_nop 1
    v_mfma_f32_16x16x32_bf16 v[60:63], v[8:11], v[152:155], v[60:63]
    v_and_b32_dpp v12, v32, v4 row_newbcast:14 row_mask:0xf bank_mask:0xf
    v_and_b32_dpp v13, v32, v5 row_newbcast:14 row_mask:0xf bank_mask:0xf
    v_and_b32_dpp v14, v32, v6 row_newbcast:14 row_mask:0xf bank_mask:0xf
    v_and_b32_dpp v15, v32, v7 row_newbcast:14 row_mask:0xf bank_mask:0xf
    s_waitcnt vmcnt(4)
    buffer_load_dwordx4 v[132:135], v22, s[24:27], s60 offen offset:1024 nt
    v_mfma_f32_16x16x32_bf16 v[60:63], v[12:15], v[156:159], v[60:63]
    v_and_b32_dpp v8, v32, v4 row_newbcast:1 row_mask:0xf bank_mask:0xf
    v_and_b32_dpp v9, v32, v5 row_newbcast:1 row_mask:0xf bank_mask:0xf
    v_and_b32_dpp v10, v32, v6 row_newbcast:1 row_mask:0xf bank_mask:0xf
    v_and_b32_dpp v11, v32, v7 row_newbcast:1 row_mask:0xf bank_mask:0xf
    s_nop 1
    v_mfma_f32_16x16x32_bf16 v[60:63], v[8:11], v[160:163], v[60:63]
    v_and_b32_dpp v12, v32, v4 row_newbcast:9 row_mask:0xf bank_mask:0xf
    v_and_b32_dpp v13, v32, v5 row_newbcast:9 row_mask:0xf bank_mask:0xf
    v_and_b32_dpp v14, v32, v6 row_newbcast:9 row_mask:0xf bank_mask:0xf
    v_and_b32_dpp v15, v32, v7 row_newbcast:9 row_mask:0xf bank_mask:0xf
    s_nop 1
    v_mfma_f32_16x16x32_bf16 v[60:63], v[12:15], v[164:167], v[60:63]
    v_and_b32_dpp v8, v32, v4 row_newbcast:5 row_mask:0xf bank_mask:0xf
    v_and_b32_dpp v9, v32, v5 row_newbcast:5 row_mask:0xf bank_mask:0xf
    v_and_b32_dpp v10, v32, v6 row_newbcast:5 row_mask:0xf bank_mask:0xf
    v_and_b32_dpp v11, v32, v7 row_newbcast:5 row_mask:0xf bank_mask:0xf
    s_waitcnt vmcnt(4)
    buffer_load_dwordx4 v[136:139], v22, s[24:27], s60 offen offset:2048 nt
    v_mfma_f32_16x16x32_bf16 v[60:63], v[8:11], v[168:171], v[60:63]
    v_and_b32_dpp v12, v32, v4 row_newbcast:13 row_mask:0xf bank_mask:0xf
    v_and_b32_dpp v13, v32, v5 row_newbcast:13 row_mask:0xf bank_mask:0xf
    v_and_b32_dpp v14, v32, v6 row_newbcast:13 row_mask:0xf bank_mask:0xf
    v_and_b32_dpp v15, v32, v7 row_newbcast:13 row_mask:0xf bank_mask:0xf
    s_nop 1
    v_mfma_f32_16x16x32_bf16 v[60:63], v[12:15], v[172:175], v[60:63]
    v_and_b32_dpp v8, v32, v4 row_newbcast:3 row_mask:0xf bank_mask:0xf
    v_and_b32_dpp v9, v32, v5 row_newbcast:3 row_mask:0xf bank_mask:0xf
    v_and_b32_dpp v10, v32, v6 row_newbcast:3 row_mask:0xf bank_mask:0xf
    v_and_b32_dpp v11, v32, v7 row_newbcast:3 row_mask:0xf bank_mask:0xf
    s_nop 1
    v_mfma_f32_16x16x32_bf16 v[60:63], v[8:11], v[176:179], v[60:63]
    v_and_b32_dpp v12, v32, v4 row_newbcast:11 row_mask:0xf bank_mask:0xf
    v_and_b32_dpp v13, v32, v5 row_newbcast:11 row_mask:0xf bank_mask:0xf
    v_and_b32_dpp v14, v32, v6 row_newbcast:11 row_mask:0xf bank_mask:0xf
    v_and_b32_dpp v15, v32, v7 row_newbcast:11 row_mask:0xf bank_mask:0xf
    s_waitcnt vmcnt(4)
    buffer_load_dwordx4 v[140:143], v22, s[24:27], s60 offen offset:3072 nt
    s_or_b32 s60, s60, 0x13000
    s_add_u32 s60, s60, 0x4000
    s_and_b32 s60, s60, 0xecfff
    s_add_u32 s63, s63, 1
    s_cmp_lg_u32 s63, s40
    s_cselect_b64 s[24:25], s[24:25], s[28:29]
    s_cselect_b64 s[28:29], s[28:29], s[30:31]
    s_cselect_b64 s[30:31], s[30:31], s[36:37]
    s_cselect_b64 s[36:37], s[36:37], s[42:43]
    s_cselect_b32 s3, 0, s41
    s_cselect_b32 s41, s41, 32
    s_add_u32 s40, s40, s3
    v_mfma_f32_16x16x32_bf16 v[60:63], v[12:15], v[180:183], v[60:63]
    v_and_b32_dpp v8, v32, v4 row_newbcast:7 row_mask:0xf bank_mask:0xf
    v_and_b32_dpp v9, v32, v5 row_newbcast:7 row_mask:0xf bank_mask:0xf
    v_and_b32_dpp v10, v32, v6 row_newbcast:7 row_mask:0xf bank_mask:0xf
    v_and_b32_dpp v11, v32, v7 row_newbcast:7 row_mask:0xf bank_mask:0xf
    s_nop 1
    v_mfma_f32_16x16x32_bf16 v[60:63], v[8:11], v[184:187], v[60:63]
    v_and_b32_dpp v12, v32, v4 row_newbcast:15 row_mask:0xf bank_mask:0xf
    v_and_b32_dpp v13, v32, v5 row_newbcast:15 row_mask:0xf bank_mask:0xf
    v_and_b32_dpp v14, v32, v6 row_newbcast:15 row_mask:0xf bank_mask:0xf
    v_and_b32_dpp v15, v32, v7 row_newbcast:15 row_mask:0xf bank_mask:0xf
    s_waitcnt vmcnt(4)
    s_nop 0
    v_mfma_f32_16x16x32_bf16 v[60:63], v[12:15], v[188:191], v[60:63]
    buffer_load_dwordx4 v[144:147], v22, s[24:27], s60 offen nt
    s_nop 6
    v_mul_f32 v60, v60, v20
    v_mul_f32 v61, v61, v20
    v_mul_f32 v62, v62, v20
    v_mul_f32 v63, v63, v20
    s_mov_b32 exec_hi, 0
    ds_write_b128 v16, v[60:63] offset:0
    s_mov_b64 exec, -1
    s_waitcnt vmcnt(4)
    buffer_load_dwordx4 v[148:151], v22, s[24:27], s60 offen offset:1024 nt
    s_waitcnt lgkmcnt(0)
    s_mov_b64 exec, 1
    ds_add_u32 v24, v23 offset:4232
    s_mov_b64 exec, -1
    s_mov_b32 s70, 0
L_w35:
    ds_read_b32 v19, v24 offset:4228
    s_add_u32 s70, s70, 1
    s_waitcnt lgkmcnt(0)
    v_readfirstlane_b32 s3, v19
    s_cmp_ge_u32 s70, 0x100000
    s_cbranch_scc1 L_w35_ok
    s_cmp_ge_u32 s3, 1
    s_cbranch_scc0 L_w35
L_w35_ok:
    v_lshlrev_b32 v17, 5, v3
    ds_read_b128 v[32:35], v17 offset:15872
    ds_read_b128 v[36:39], v17 offset:15888
    s_waitcnt vmcnt(4)
    buffer_load_dwordx4 v[152:155], v22, s[24:27], s60 offen offset:2048 nt
    s_waitcnt vmcnt(4)
    buffer_load_dwordx4 v[156:159], v22, s[24:27], s60 offen offset:3072 nt
    s_or_b32 s60, s60, 0x13000
    s_add_u32 s60, s60, 0x4000
    s_and_b32 s60, s60, 0xecfff
    s_add_u32 s63, s63, 1
    s_cmp_lg_u32 s63, s40
    s_cselect_b64 s[24:25], s[24:25], s[28:29]
    s_cselect_b64 s[28:29], s[28:29], s[30:31]
    s_cselect_b64 s[30:31], s[30:31], s[36:37]
    s_cselect_b64 s[36:37], s[36:37], s[42:43]
    s_cselect_b32 s3, 0, s41
    s_cselect_b32 s41, s41, 32
    s_add_u32 s40, s40, s3
    s_waitcnt lgkmcnt(0)
    v_cvt_pk_bf16_f32 v28, v32, v33
    v_cvt_pk_bf16_f32 v29, v34, v35
    v_cvt_pk_bf16_f32 v30, v36, v37
    v_cvt_pk_bf16_f32 v31, v38, v39
    s_mov_b32 s73, 8
    s_nop 0
L_kB1:
    s_waitcnt lgkmcnt(0)
    s_add_u32 s39, s39, 4
    v_readfirstlane_b32 s74, v70
    v_mov_b32 v71, s39
    ds_write_b32 v25, v71 offset:4256
    ds_read_b32 v70, v25 offset:4272
    s_waitcnt vmcnt(5)
    s_add_u32 s75, s75, s74
    s_cbranch_scc1 L_f36
    s_waitcnt vmcnt(4)
L_f36:
    buffer_load_dwordx4 v[160:163], v22, s[24:27], s60 offen nt
    v_dot2_f32_bf16 v48, v128, v28, 0
    v_dot2_f32_bf16 v48, v129, v29, v48
    v_dot2_f32_bf16 v48, v130, v30, v48
    v_dot2_f32_bf16 v48, v131, v31, v48
    v_add_f32_dpp v53, v50, v50 row_ror:8 row_mask:0xf bank_mask:0x3
    v_add_f32_dpp v53, v51, v51 row_ror:8 row_mask:0xf bank_mask:0xc
    s_waitcnt vmcnt(5)
    s_add_u32 s75, s75, s74
    s_cbranch_scc1 L_f37
    s_waitcnt vmcnt(4)
L_f37:
    buffer_load_dwordx4 v[164:167], v22, s[24:27], s60 offen offset:1024 nt
    v_dot2_f32_bf16 v49, v132, v28, 0
    v_dot2_f32_bf16 v49, v133, v29, v49
    v_dot2_f32_bf16 v49, v134, v30, v49
    v_dot2_f32_bf16 v49, v135, v31, v49
    v_add_f32_dpp v55, v52, v52 row_half_mirror row_mask:0xf bank_mask:0x5
    v_add_f32_dpp v55, v53, v53 row_half_mirror row_mask:0xf bank_mask:0xa
    s_waitcnt vmcnt(5)
    s_add_u32 s75, s75, s74
    s_cbranch_scc1 L_f38
    s_waitcnt vmcnt(4)
L_f38:
    buffer_load_dwordx4 v[168:171], v22, s[24:27], s60 offen offset:2048 nt
    v_dot2_f32_bf16 v50, v136, v28, 0
    v_dot2_f32_bf16 v50, v137, v29, v50
    v_dot2_f32_bf16 v50, v138, v30, v50
    v_dot2_f32_bf16 v50, v139, v31, v50
    v_add_f32_dpp v58, v54, v54 quad_perm:[2,3,0,1] row_mask:0xf bank_mask:0xf
    v_add_f32_dpp v59, v55, v55 quad_perm:[2,3,0,1] row_mask:0xf bank_mask:0xf
    v_cndmask_b32_e64 v57, v58, v59, s[64:65]
    s_waitcnt vmcnt(5)
    s_add_u32 s75, s75, s74
    s_cbranch_scc1 L_f39
    s_waitcnt vmcnt(4)
L_f39:
    buffer_load_dwordx4 v[172:175], v22, s[24:27], s60 offen offset:3072 nt
    s_or_b32 s60, s60, 0x13000
    s_add_u32 s60, s60, 0x4000
    s_and_b32 s60, s60, 0xecfff
    s_add_u32 s63, s63, 1
    s_cmp_lg_u32 s63, s40
    s_cselect_b64 s[24:25], s[24:25], s[28:29]
    s_cselect_b64 s[28:29], s[28:29], s[30:31]
    s_cselect_b64 s[30:31], s[30:31], s[36:37]
    s_cselect_b64 s[36:37], s[36:37], s[42:43]
    s_cselect_b32 s3, 0, s41
    s_cselect_b32 s41, s41, 32
    s_add_u32 s40, s40, s3
    v_dot2_f32_bf16 v51, v140, v28, 0
    v_dot2_f32_bf16 v51, v141, v29, v51
    v_dot2_f32_bf16 v51, v142, v30, v51
    v_dot2_f32_bf16 v51, v143, v31, v51
    v_add_f32_dpp v52, v48, v48 row_ror:8 row_mask:0xf bank_mask:0x3
    v_add_f32_dpp v52, v49, v49 row_ror:8 row_mask:0xf bank_mask:0xc
    s_waitcnt lgkmcnt(0)
    s_add_u32 s39, s39, 4
    v_readfirstlane_b32 s74, v70
    v_mov_b32 v71, s39
    ds_write_b32 v25, v71 offset:4256
    ds_read_b32 v70, v25 offset:4272
    s_waitcnt vmcnt(5)
    s_add_u32 s75, s75, s74
    s_cbranch_scc1 L_f40
    s_waitcnt vmcnt(4)
L_f40:
    buffer_load_dwordx4 v[176:179], v22, s[24:27], s60 offen nt
    v_dot2_f32_bf16 v48, v144, v28, 0
    v_dot2_f32_bf16 v48, v145, v29, v48
    v_dot2_f32_bf16 v48, v146, v30, v48
    v_dot2_f32_bf16 v48, v147, v31, v48
    v_add_f32_dpp v58, v56, v56 quad_perm:[1,0,3,2] row_mask:0xf bank_mask:0xf
    v_add_f32_dpp v59, v57, v57 quad_perm:[1,0,3,2] row_mask:0xf bank_mask:0xf
    v_mov_b32 v32, v33
    v_mov_b32 v33, v34
    v_mov_b32 v34, v35
    v_mov_b32 v35, v36
    v_mov_b32 v36, v37
    v_mov_b32 v37, v38
    v_mov_b32 v38, v39
    v_cndmask_b32_e64 v39, v58, v59, s[66:67]
    s_waitcnt vmcnt(5)
    s_add_u32 s75, s75, s74
    s_cbranch_scc1 L_f41
    s_waitcnt vmcnt(4)
L_f41:
    buffer_load_dwordx4 v[180:183], v22, s[24:27], s60 offen offset:1024 nt
    v_dot2_f32_bf16 v49, v148, v28, 0
    v_dot2_f32_bf16 v49, v149, v29, v49
    v_dot2_f32_bf16 v49, v150, v30, v49
    v_dot2_f32_bf16 v49, v151, v31, v49
    v_add_f32_dpp v53, v50, v50 row_ror:8 row_mask:0xf bank_mask:0x3
    v_add_f32_dpp v53, v51, v51 row_ror:8 row_mask:0xf bank_mask:0xc
    s_waitcnt vmcnt(5)
    s_add_u32 s75, s75, s74
    s_cbranch_scc1 L_f42
    s_waitcnt vmcnt(4)
L_f42:
    buffer_load_dwordx4 v[184:187], v22, s[24:27], s60 offen offset:2048 nt
    v_dot2_f32_bf16 v50, v152, v28, 0
    v_dot2_f32_bf16 v50, v153, v29, v50
    v_dot2_f32_bf16 v50, v154, v30, v50
    v_dot2_f32_bf16 v50, v155, v31, v50
    v_add_f32_dpp v54, v52, v52 row_half_mirror row_mask:0xf bank_mask:0x5
    v_add_f32_dpp v54, v53, v53 row_half_mirror row_mask:0xf bank_mask:0xa
    s_waitcnt vmcnt(5)
    s_add_u32 s75, s75, s74
    s_cbranch_scc1 L_f43
    s_waitcnt vmcnt(4)
L_f43:
    buffer_load_dwordx4 v[188:191], v22, s[24:27], s60 offen offset:3072 nt
    s_or_b32 s60, s60, 0x13000
    s_add_u32 s60, s60, 0x4000
    s_and_b32 s60, s60, 0xecfff
    s_add_u32 s63, s63, 1
    s_cmp_lg_u32 s63, s40
    s_cselect_b64 s[24:25], s[24:25], s[28:29]
    s_cselect_b64 s[28:29], s[28:29], s[30:31]
    s_cselect_b64 s[30:31], s[30:31], s[36:37]
    s_cselect_b64 s[36:37], s[36:37], s[42:43]
    s_cselect_b32 s3, 0, s41
    s_cselect_b32 s41, s41, 32
    s_add_u32 s40, s40, s3
    v_dot2_f32_bf16 v51, v156, v28, 0
    v_dot2_f32_bf16 v51, v157, v29, v51
    v_dot2_f32_bf16 v51, v158, v30, v51
    v_dot2_f32_bf16 v51, v159, v31, v51
    v_add_f32_dpp v52, v48, v48 row_ror:8 row_mask:0xf bank_mask:0x3
    v_add_f32_dpp v52, v49, v49 row_ror:8 row_mask:0xf bank_mask:0xc
    s_waitcnt lgkmcnt(0)
    s_add_u32 s39, s39, 4
    v_readfirstlane_b32 s74, v70
    v_mov_b32 v71, s39
    ds_write_b32 v25, v71 offset:4256
    ds_read_b32 v70, v25 offset:4272
    s_waitcnt vmcnt(5)
    s_add_u32 s75, s75, s74
    s_cbranch_scc1 L_f44
    s_waitcnt vmcnt(4)
L_f44:
    buffer_load_dwordx4 v[128:131], v22, s[24:27], s60 offen nt
    v_dot2_f32_bf16 v48, v160, v28, 0
    v_dot2_f32_bf16 v48, v161, v29, v48
    v_dot2_f32_bf16 v48, v162, v30, v48
    v_dot2_f32_bf16 v48, v163, v31, v48
    v_add_f32_dpp v53, v50, v50 row_ror:8 row_mask:0xf bank_mask:0x3
    v_add_f32_dpp v53, v51, v51 row_ror:8 row_mask:0xf bank_mask:0xc
    s_waitcnt vmcnt(5)
    s_add_u32 s75, s75, s74
    s_cbranch_scc1 L_f45
    s_waitcnt vmcnt(4)
L_f45:
    buffer_load_dwordx4 v[132:135], v22, s[24:27], s60 offen offset:1024 nt
    v_dot2_f32_bf16 v49, v164, v28, 0
    v_dot2_f32_bf16 v49, v165, v29, v49
    v_dot2_f32_bf16 v49, v166, v30, v49
    v_dot2_f32_bf16 v49, v167, v31, v49
    v_add_f32_dpp v55, v52, v52 row_half_mirror row_mask:0xf bank_mask:0x5
    v_add_f32_dpp v55, v53, v53 row_half_mirror row_mask:0xf bank_mask:0xa
    s_waitcnt vmcnt(5)
    s_add_u32 s75, s75, s74
    s_cbranch_scc1 L_f46
    s_waitcnt vmcnt(4)
L_f46:
    buffer_load_dwordx4 v[136:139], v22, s[24:27], s60 offen offset:2048 nt
    v_dot2_f32_bf16 v50, v168, v28, 0
    v_dot2_f32_bf16 v50, v169, v29, v50
    v_dot2_f32_bf16 v50, v170, v30, v50
    v_dot2_f32_bf16 v50, v171, v31, v50
    v_add_f32_dpp v58, v54, v54 quad_perm:[2,3,0,1] row_mask:0xf bank_mask:0xf
    v_add_f32_dpp v59, v55, v55 quad_perm:[2,3,0,1] row_mask:0xf bank_mask:0xf
    v_cndmask_b32_e64 v56, v58, v59, s[64:65]
    s_waitcnt vmcnt(5)
    s_add_u32 s75, s75, s74
    s_cbranch_scc1 L_f47
    s_waitcnt vmcnt(4)
L_f47:
    buffer_load_dwordx4 v[140:143], v22, s[24:27], s60 offen offset:3072 nt
    s_or_b32 s60, s60, 0x13000
    s_add_u32 s60, s60, 0x4000
    s_and_b32 s60, s60, 0xecfff
    s_add_u32 s63, s63, 1
    s_cmp_lg_u32 s63, s40
    s_cselect_b64 s[24:25], s[24:25], s[28:29]
    s_cselect_b64 s[28:29], s[28:29], s[30:31]
    s_cselect_b64 s[30:31], s[30:31], s[36:37]
    s_cselect_b64 s[36:37], s[36:37], s[42:43]
    s_cselect_b32 s3, 0, s41
    s_cselect_b32 s41, s41, 32
    s_add_u32 s40, s40, s3
    v_dot2_f32_bf16 v51, v172, v28, 0
    v_dot2_f32_bf16 v51, v173, v29, v51
    v_dot2_f32_bf16 v51, v174, v30, v51
    v_dot2_f32_bf16 v51, v175, v31, v51
    v_add_f32_dpp v52, v48, v48 row_ror:8 row_mask:0xf bank_mask:0x3
    v_add_f32_dpp v52, v49, v49 row_ror:8 row_mask:0xf bank_mask:0xc
    s_waitcnt lgkmcnt(0)
    s_add_u32 s39, s39, 4
    v_readfirstlane_b32 s74, v70
    v_mov_b32 v71, s39
    ds_write_b32 v25, v71 offset:4256
    ds_read_b32 v70, v25 offset:4272
    s_waitcnt vmcnt(5)
    s_add_u32 s75, s75, s74
    s_cbranch_scc1 L_f48
    s_waitcnt vmcnt(4)
L_f48:
    buffer_load_dwordx4 v[144:147], v22, s[24:27], s60 offen nt
    v_dot2_f32_bf16 v48, v176, v28, 0
    v_dot2_f32_bf16 v48, v177, v29, v48
    v_dot2_f32_bf16 v48, v178, v30, v48
    v_dot2_f32_bf16 v48, v179, v31, v48
    v_add_f32_dpp v53, v50, v50 row_ror:8 row_mask:0xf bank_mask:0x3
    v_add_f32_dpp v53, v51, v51 row_ror:8 row_mask:0xf bank_mask:0xc
    s_waitcnt vmcnt(5)
    s_add_u32 s75, s75, s74
    s_cbranch_scc1 L_f49
    s_waitcnt vmcnt(4)
L_f49:
    buffer_load_dwordx4 v[148:151], v22, s[24:27], s60 offen offset:1024 nt
    v_dot2_f32_bf16 v49, v180, v28, 0
    v_dot2_f32_bf16 v49, v181, v29, v49
    v_dot2_f32_bf16 v49, v182, v30, v49
    v_dot2_f32_bf16 v49, v183, v31, v49
    v_add_f32_dpp v54, v52, v52 row_half_mirror row_mask:0xf bank_mask:0x5
    v_add_f32_dpp v54, v53, v53 row_half_mirror row_mask:0xf bank_mask:0xa
    s_waitcnt vmcnt(5)
    s_add_u32 s75, s75, s74
    s_cbranch_scc1 L_f50
    s_waitcnt vmcnt(4)
L_f50:
    buffer_load_dwordx4 v[152:155], v22, s[24:27], s60 offen offset:2048 nt
    v_dot2_f32_bf16 v50, v184, v28, 0
    v_dot2_f32_bf16 v50, v185, v29, v50
    v_dot2_f32_bf16 v50, v186, v30, v50
    v_dot2_f32_bf16 v50, v187, v31, v50
    v_add_f32_dpp v52, v48, v48 row_ror:8 row_mask:0xf bank_mask:0x3
    v_add_f32_dpp v52, v49, v49 row_ror:8 row_mask:0xf bank_mask:0xc
    s_waitcnt vmcnt(5)
    s_add_u32 s75, s75, s74
    s_cbranch_scc1 L_f51
    s_waitcnt vmcnt(4)
L_f51:
    buffer_load_dwordx4 v[156:159], v22, s[24:27], s60 offen offset:3072 nt
    s_or_b32 s60, s60, 0x13000
    s_add_u32 s60, s60, 0x4000
    s_and_b32 s60, s60, 0xecfff
    s_add_u32 s63, s63, 1
    s_cmp_lg_u32 s63, s40
    s_cselect_b64 s[24:25], s[24:25], s[28:29]
    s_cselect_b64 s[28:29], s[28:29], s[30:31]
    s_cselect_b64 s[30:31], s[30:31], s[36:37]
    s_cselect_b64 s[36:37], s[36:37], s[42:43]
    s_cselect_b32 s3, 0, s41
    s_cselect_b32 s41, s41, 32
    s_add_u32 s40, s40, s3
    v_dot2_f32_bf16 v51, v188, v28, 0
    v_dot2_f32_bf16 v51, v189, v29, v51
    v_dot2_f32_bf16 v51, v190, v30, v51
    v_dot2_f32_bf16 v51, v191, v31, v51
    s_sub_u32 s73, s73, 1
    s_cmp_lg_u32 s73, 0
    s_nop 0
    s_cbranch_scc1 L_kB1
    s_waitcnt vmcnt(4)
    buffer_load_dwordx4 v[160:163], v22, s[24:27], s60 offen nt
    v_add_f32_dpp v53, v50, v50 row_ror:8 row_mask:0xf bank_mask:0x3
    v_add_f32_dpp v53, v51, v51 row_ror:8 row_mask:0xf bank_mask:0xc
    v_add_f32_dpp v55, v52, v52 row_half_mirror row_mask:0xf bank_mask:0x5
    s_nop 0
    v_add_f32_dpp v55, v53, v53 row_half_mirror row_mask:0xf bank_mask:0xa
    v_add_f32_dpp v58, v54, v54 quad_perm:[2,3,0,1] row_mask:0xf bank_mask:0xf
    s_nop 0
    v_add_f32_dpp v59, v55, v55 quad_perm:[2,3,0,1] row_mask:0xf bank_mask:0xf
    v_cndmask_b32_e64 v57, v58, v59, s[64:65]
    v_add_f32_dpp v58, v56, v56 quad_perm:[1,0,3,2] row_mask:0xf bank_mask:0xf
    s_nop 0
    v_add_f32_dpp v59, v57, v57 quad_perm:[1,0,3,2] row_mask:0xf bank_mask:0xf
    v_mov_b32 v32, v33
    v_mov_b32 v33, v34
    v_mov_b32 v34, v35
    v_mov_b32 v35, v36
    v_mov_b32 v36, v37
    v_mov_b32 v37, v38
    v_mov_b32 v38, v39
    v_cndmask_b32_e64 v39, v58, v59, s[66:67]
    v_max3_f32 v17, v32, v33, v34
    v_max3_f32 v17, v17, v35, v36
    v_max3_f32 v17, v17, v37, v38
    v_max_f32 v17, v17, v39
    s_nop 1
    v_max_f32_dpp v17, v17, v17 row_ror:8 row_mask:0xf bank_mask:0xf
    s_nop 1
    v_max_f32_dpp v17, v17, v17 row_ror:4 row_mask:0xf bank_mask:0xf
    s_nop 1
    v_max_f32_dpp v17, v17, v17 row_ror:2 row_mask:0xf bank_mask:0xf
    s_nop 1
    v_max_f32_dpp v17, v17, v17 row_ror:1 row_mask:0xf bank_mask:0xf
    s_nop 1
    v_max_f32_dpp v17, v17, v17 row_bcast:15 row_mask:0xa bank_mask:0xf
    s_nop 1
    v_max_f32_dpp v17, v17, v17 row_bcast:31 row_mask:0xc bank_mask:0xf
    s_nop 0
    v_readlane_b32 s68, v17, 63
    s_waitcnt vmcnt(4)
    buffer_load_dwordx4 v[164:167], v22, s[24:27], s60 offen offset:1024 nt
    v_mov_b32 v20, s68
    v_mul_f32 v20, s72, v20
    v_fma_f32 v32, v32, s72, -v20
    v_fma_f32 v33, v33, s72, -v20
    v_fma_f32 v34, v34, s72, -v20
    v_fma_f32 v35, v35, s72, -v20
    v_fma_f32 v36, v36, s72, -v20
    v_fma_f32 v37, v37, s72, -v20
    v_fma_f32 v38, v38, s72, -v20
    v_fma_f32 v39, v39, s72, -v20
    v_exp_f32 v32, v32
    v_exp_f32 v33, v33
    v_exp_f32 v34, v34
    v_exp_f32 v35, v35
    v_exp_f32 v36, v36
    v_exp_f32 v37, v37
    v_exp_f32 v38, v38
    v_exp_f32 v39, v39
    s_waitcnt vmcnt(4)
    buffer_load_dwordx4 v[168:171], v22, s[24:27], s60 offen offset:2048 nt
    v_add_f32 v17, v32, v33
    v_add_f32 v17, v17, v34
    v_add_f32 v17, v17, v35
    v_add_f32 v17, v17, v36
    v_add_f32 v17, v17, v37
    v_add_f32 v17, v17, v38
    v_add_f32 v17, v17, v39
    v_cvt_pk_bf16_f32 v32, v32, v32
    v_cvt_pk_bf16_f32 v33, v33, v33
    v_cvt_pk_bf16_f32 v34, v34, v34
    v_cvt_pk_bf16_f32 v35, v35, v35
    v_cvt_pk_bf16_f32 v36, v36, v36
    v_cvt_pk_bf16_f32 v37, v37, v37
    v_cvt_pk_bf16_f32 v38, v38, v38
    v_cvt_pk_bf16_f32 v39, v39, v39
    v_add_f32_dpp v17, v17, v17 row_ror:8 row_mask:0xf bank_mask:0xf
    s_nop 1
    v_add_f32_dpp v17, v17, v17 row_ror:4 row_mask:0xf bank_mask:0xf
    s_nop 1
    v_add_f32_dpp v17, v17, v17 row_ror:2 row_mask:0xf bank_mask:0xf
    s_nop 1
    v_add_f32_dpp v17, v17, v17 row_ror:1 row_mask:0xf bank_mask:0xf
    s_nop 1
    v_add_f32_dpp v17, v17, v17 row_bcast:15 row_mask:0xa bank_mask:0xf
    s_nop 1
    v_add_f32_dpp v17, v17, v17 row_bcast:31 row_mask:0xc bank_mask:0xf
    s_nop 0
    v_readlane_b32 s69, v17, 63
    s_waitcnt vmcnt(4)
    buffer_load_dwordx4 v[172:175], v22, s[24:27], s60 offen offset:3072 nt
    s_or_b32 s60, s60, 0x13000
    s_add_u32 s60, s60, 0x4000
    s_and_b32 s60, s60, 0xecfff
    s_add_u32 s63, s63, 1
    s_cmp_lg_u32 s63, s40
    s_cselect_b64 s[24:25], s[24:25], s[28:29]
    s_cselect_b64 s[28:29], s[28:29], s[30:31]
    s_cselect_b64 s[30:31], s[30:31], s[36:37]
    s_cselect_b64 s[36:37], s[36:37], s[42:43]
    s_cselect_b32 s3, 0, s41
    s_cselect_b32 s41, s41, 32
    s_add_u32 s40, s40, s3
    v_mov_b32 v21, s69
    s_lshl_b32 s3, s56, 3
    v_mov_b32 v17, s3
    s_mov_b64 exec, 1
    ds_write_b64 v17, v[20:21] offset:4160
    s_mov_b64 exec, -1
    v_mov_b32 v60, 0
    v_mov_b32 v61, 0
    v_mov_b32 v62, 0
    v_mov_b32 v63, 0
    v_and_b32_dpp v8, v32, v4 row_newbcast:0 row_mask:0xf bank_mask:0xf
    v_and_b32_dpp v9, v32, v5 row_newbcast:0 row_mask:0xf bank_mask:0xf
    v_and_b32_dpp v10, v32, v6 row_newbcast:0 row_mask:0xf bank_mask:0xf
    v_and_b32_dpp v11, v32, v7 row_newbcast:0 row_mask:0xf bank_mask:0xf
    s_mov_b32 s73, 6
    s_nop 0
L_vB1:
    s_waitcnt lgkmcnt(0)
    s_add_u32 s39, s39, 4
    v_readfirstlane_b32 s74, v70
    v_mov_b32 v71, s39
    ds_write_b32 v25, v71 offset:4256
    ds_read_b32 v70, v25 offset:4272
    s_waitcnt vmcnt(5)
    s_add_u32 s75, s75, s74
    s_cbranch_scc1 L_f52
    s_waitcnt vmcnt(4)
L_f52:
    buffer_load_dwordx4 v[176:179], v22, s[24:27], s60 offen nt
    v_mfma_f32_16x16x32_bf16 v[60:63], v[8:11], v[128:131], v[60:63]
    v_and_b32_dpp v12, v32, v4 row_newbcast:8 row_mask:0xf bank_mask:0xf
    v_and_b32_dpp v13, v32, v5 row_newbcast:8 row_mask:0xf bank_mask:0xf
    v_and_b32_dpp v14, v32, v6 row_newbcast:8 row_mask:0xf bank_mask:0xf
    v_and_b32_dpp v15, v32, v7 row_newbcast:8 row_mask:0xf bank_mask:0xf
    s_waitcnt vmcnt(5)
    s_add_u32 s75, s75, s74
    s_cbranch_scc1 L_f53
    s_waitcnt vmcnt(4)
L_f53:
    buffer_load_dwordx4 v[180:183], v22, s[24:27], s60 offen offset:1024 nt
    v_mfma_f32_16x16x32_bf16 v[60:63], v[12:15], v[132:135], v[60:63]
    v_and_b32_dpp v8, v32, v4 row_newbcast:4 row_mask:0xf bank_mask:0xf
    v_and_b32_dpp v9, v32, v5 row_newbcast:4 row_mask:0xf bank_mask:0xf
    v_and_b32_dpp v10, v32, v6 row_newbcast:4 row_mask:0xf bank_mask:0xf
    v_and_b32_dpp v11, v32, v7 row_newbcast:4 row_mask:0xf bank_mask:0xf
    s_waitcnt vmcnt(5)
    s_add_u32 s75, s75, s74
    s_cbranch_scc1 L_f54
    s_waitcnt vmcnt(4)
L_f54:
    buffer_load_dwordx4 v[184:187], v22, s[24:27], s60 offen offset:2048 nt
    v_mfma_f32_16x16x32_bf16 v[60:63], v[8:11], v[136:139], v[60:63]
    v_and_b32_dpp v12, v32, v4 row_newbcast:12 row_mask:0xf bank_mask:0xf
    v_and_b32_dpp v13, v32, v5 row_newbcast:12 row_mask:0xf bank_mask:0xf
    v_and_b32_dpp v14, v32, v6 row_newbcast:12 row_mask:0xf bank_mask:0xf
    v_and_b32_dpp v15, v32, v7 row_newbcast:12 row_mask:0xf bank_mask:0xf
    s_waitcnt vmcnt(5)
    s_add_u32 s75, s75, s74
    s_cbranch_scc1 L_f55
    s_waitcnt vmcnt(4)
L_f55:
    buffer_load_dwordx4 v[188:191], v22, s[24:27], s60 offen offset:3072 nt
    s_or_b32 s60, s60, 0x13000
    s_add_u32 s60, s60, 0x4000
    s_and_b32 s60, s60, 0xecfff
    s_add_u32 s63, s63, 1
    s_cmp_lg_u32 s63, s40
    s_cselect_b64 s[24:25], s[24:25], s[28:29]
    s_cselect_b64 s[28:29], s[28:29], s[30:31]
    s_cselect_b64 s[30:31], s[30:31], s[36:37]
    s_cselect_b64 s[36:37], s[36:37], s[42:43]
    s_cselect_b32 s3, 0, s41
    s_cselect_b32 s41, s41, 32
    s_add_u32 s40, s40, s3
    v_mfma_f32_16x16x32_bf16 v[60:63], v[12:15], v[140:143], v[60:63]
    v_and_b32_dpp v8, v32, v4 row_newbcast:2 row_mask:0xf bank_mask:0xf
    v_and_b32_dpp v9, v32, v5 row_newbcast:2 row_mask:0xf bank_mask:0xf
    v_and_b32_dpp v10, v32, v6 row_newbcast:2 row_mask:0xf bank_mask:0xf
    v_and_b32_dpp v11, v32, v7 row_newbcast:2 row_mask:0xf bank_mask:0xf
    s_waitcnt lgkmcnt(0)
    s_add_u32 s39, s39, 4
    v_readfirstlane_b32 s74, v70
    v_mov_b32 v71, s39
    ds_write_b32 v25, v71 offset:4256
    ds_read_b32 v70, v25 offset:4272
    s_waitcnt vmcnt(5)
    s_add_u32 s75, s75, s74
    s_cbranch_scc1 L_f56
    s_waitcnt vmcnt(4)
L_f56:
    buffer_load_dwordx4 v[128:131], v22, s[24:27], s60 offen nt
    v_mfma_f32_16x16x32_bf16 v[60:63], v[8:11], v[144:147], v[60:63]
    v_and_b32_dpp v12, v32, v4 row_newbcast:10 row_mask:0xf bank_mask:0xf
    v_and_b32_dpp v13, v32, v5 row_newbcast:10 row_mask:0xf bank_mask:0xf
    v_and_b32_dpp v14, v32, v6 row_newbcast:10 row_mask:0xf bank_mask:0xf
    v_and_b32_dpp v15, v32, v7 row_newbcast:10 row_mask:0xf bank_mask:0xf
    s_waitcnt vmcnt(5)
    s_add_u32 s75, s75, s74
    s_cbranch_scc1 L_f57
    s_waitcnt vmcnt(4)
L_f57:
    buffer_load_dwordx4 v[132:135], v22, s[24:27], s60 offen offset:1024 nt
    v_mfma_f32_16x16x32_bf16 v[60:63], v[12:15], v[148:151], v[60:63]
    v_and_b32_dpp v8, v32, v4 row_newbcast:6 row_mask:0xf bank_mask:0xf
    v_and_b32_dpp v9, v32, v5 row_newbcast:6 row_mask:0xf bank_mask:0xf
    v_and_b32_dpp v10, v32, v6 row_newbcast:6 row_mask:0xf bank_mask:0xf
    v_and_b32_dpp v11, v32, v7 row_newbcast:6 row_mask:0xf bank_mask:0xf
    s_waitcnt vmcnt(5)
    s_add_u32 s75, s75, s74
    s_cbranch_scc1 L_f58
    s_waitcnt vmcnt(4)
L_f58:
    buffer_load_dwordx4 v[136:139], v22, s[24:27], s60 offen offset:2048 nt
    v_mfma_f32_16x16x32_bf16 v[60:63], v[8:11], v[152:155], v[60:63]
    v_and_b32_dpp v12, v32, v4 row_newbcast:14 row_mask:0xf bank_mask:0xf
    v_and_b32_dpp v13, v32, v5 row_newbcast:14 row_mask:0xf bank_mask:0xf
    v_and_b32_dpp v14, v32, v6 row_newbcast:14 row_mask:0xf bank_mask:0xf
    v_and_b32_dpp v15, v32, v7 row_newbcast:14 row_mask:0xf bank_mask:0xf
    s_waitcnt vmcnt(5)
    s_add_u32 s75, s75, s74
    s_cbranch_scc1 L_f59
    s_waitcnt vmcnt(4)
L_f59:
    buffer_load_dwordx4 v[140:143], v22, s[24:27], s60 offen offset:3072 nt
    s_or_b32 s60, s60, 0x13000
    s_add_u32 s60, s60, 0x4000
    s_and_b32 s60, s60, 0xecfff
    s_add_u32 s63, s63, 1
    s_cmp_lg_u32 s63, s40
    s_cselect_b64 s[24:25], s[24:25], s[28:29]
    s_cselect_b64 s[28:29], s[28:29], s[30:31]
    s_cselect_b64 s[30:31], s[30:31], s[36:37]
    s_cselect_b64 s[36:37], s[36:37], s[42:43]
    s_cselect_b32 s3, 0, s41
    s_cselect_b32 s41, s41, 32
    s_add_u32 s40, s40, s3
    v_mfma_f32_16x16x32_bf16 v[60:63], v[12:15], v[156:159], v[60:63]
    v_and_b32_dpp v8, v32, v4 row_newbcast:1 row_mask:0xf bank_mask:0xf
    v_and_b32_dpp v9, v32, v5 row_newbcast:1 row_mask:0xf bank_mask:0xf
    v_and_b32_dpp v10, v32, v6 row_newbcast:1 row_mask:0xf bank_mask:0xf
    v_and_b32_dpp v11, v32, v7 row_newbcast:1 row_mask:0xf bank_mask:0xf
    s_waitcnt lgkmcnt(0)
    s_add_u32 s39, s39, 4
    v_readfirstlane_b32 s74, v70
    v_mov_b32 v71, s39
    ds_write_b32 v25, v71 offset:4256
    ds_read_b32 v70, v25 offset:4272
    s_waitcnt vmcnt(5)
    s_add_u32 s75, s75, s74
    s_cbranch_scc1 L_f60
    s_waitcnt vmcnt(4)
L_f60:
    buffer_load_dwordx4 v[144:147], v22, s[24:27], s60 offen nt
    v_mfma_f32_16x16x32_bf16 v[60:63], v[8:11], v[160:163], v[60:63]
    v_and_b32_dpp v12, v32, v4 row_newbcast:9 row_mask:0xf bank_mask:0xf
    v_and_b32_dpp v13, v32, v5 row_newbcast:9 row_mask:0xf bank_mask:0xf
    v_and_b32_dpp v14, v32, v6 row_newbcast:9 row_mask:0xf bank_mask:0xf
    v_and_b32_dpp v15, v32, v7 row_newbcast:9 row_mask:0xf bank_mask:0xf
    s_waitcnt vmcnt(5)
    s_add_u32 s75, s75, s74
    s_cbranch_scc1 L_f61
    s_waitcnt vmcnt(4)
L_f61:
    buffer_load_dwordx4 v[148:151], v22, s[24:27], s60 offen offset:1024 nt
    v_mfma_f32_16x16x32_bf16 v[60:63], v[12:15], v[164:167], v[60:63]
    v_and_b32_dpp v8, v32, v4 row_newbcast:5 row_mask:0xf bank_mask:0xf
    v_and_b32_dpp v9, v32, v5 row_newbcast:5 row_mask:0xf bank_mask:0xf
    v_and_b32_dpp v10, v32, v6 row_newbcast:5 row_mask:0xf bank_mask:0xf
    v_and_b32_dpp v11, v32, v7 row_newbcast:5 row_mask:0xf bank_mask:0xf
    s_waitcnt vmcnt(5)
    s_add_u32 s75, s75, s74
    s_cbranch_scc1 L_f62
    s_waitcnt vmcnt(4)
L_f62:
    buffer_load_dwordx4 v[152:155], v22, s[24:27], s60 offen offset:2048 nt
    v_mfma_f32_16x16x32_bf16 v[60:63], v[8:11], v[168:171], v[60:63]
    v_and_b32_dpp v12, v32, v4 row_newbcast:13 row_mask:0xf bank_mask:0xf
    v_and_b32_dpp v13, v32, v5 row_newbcast:13 row_mask:0xf bank_mask:0xf
    v_and_b32_dpp v14, v32, v6 row_newbcast:13 row_mask:0xf bank_mask:0xf
    v_and_b32_dpp v15, v32, v7 row_newbcast:13 row_mask:0xf bank_mask:0xf
    s_waitcnt vmcnt(5)
    s_add_u32 s75, s75, s74
    s_cbranch_scc1 L_f63
    s_waitcnt vmcnt(4)
L_f63:
    buffer_load_dwordx4 v[156:159], v22, s[24:27], s60 offen offset:3072 nt
    s_or_b32 s60, s60, 0x13000
    s_add_u32 s60, s60, 0x4000
    s_and_b32 s60, s60, 0xecfff
    s_add_u32 s63, s63, 1
    s_cmp_lg_u32 s63, s40
    s_cselect_b64 s[24:25], s[24:25], s[28:29]
    s_cselect_b64 s[28:29], s[28:29], s[30:31]
    s_cselect_b64 s[30:31], s[30:31], s[36:37]
    s_cselect_b64 s[36:37], s[36:37], s[42:43]
    s_cselect_b32 s3, 0, s41
    s_cselect_b32 s41, s41, 32
    s_add_u32 s40, s40, s3
    v_mfma_f32_16x16x32_bf16 v[60:63], v[12:15], v[172:175], v[60:63]
    v_and_b32_dpp v8, v32, v4 row_newbcast:3 row_mask:0xf bank_mask:0xf
    v_and_b32_dpp v9, v32, v5 row_newbcast:3 row_mask:0xf bank_mask:0xf
    v_and_b32_dpp v10, v32, v6 row_newbcast:3 row_mask:0xf bank_mask:0xf
    v_and_b32_dpp v11, v32, v7 row_newbcast:3 row_mask:0xf bank_mask:0xf
    s_waitcnt lgkmcnt(0)
    s_add_u32 s39, s39, 4
    v_readfirstlane_b32 s74, v70
    v_mov_b32 v71, s39
    ds_write_b32 v25, v71 offset:4256
    ds_read_b32 v70, v25 offset:4272
    s_waitcnt vmcnt(5)
    s_add_u32 s75, s75, s74
    s_cbranch_scc1 L_f64
    s_waitcnt vmcnt(4)
L_f64:
    buffer_load_dwordx4 v[160:163], v22, s[24:27], s60 offen nt
    v_mfma_f32_16x16x32_bf16 v[60:63], v[8:11], v[176:179], v[60:63]
    v_and_b32_dpp v12, v32, v4 row_newbcast:11 row_mask:0xf bank_mask:0xf
    v_and_b32_dpp v13, v32, v5 row_newbcast:11 row_mask:0xf bank_mask:0xf
    v_and_b32_dpp v14, v32, v6 row_newbcast:11 row_mask:0xf bank_mask:0xf
    v_and_b32_dpp v15, v32, v7 row_newbcast:11 row_mask:0xf bank_mask:0xf
    s_waitcnt vmcnt(5)
    s_add_u32 s75, s75, s74
    s_cbranch_scc1 L_f65
    s_waitcnt vmcnt(4)
L_f65:
    buffer_load_dwordx4 v[164:167], v22, s[24:27], s60 offen offset:1024 nt
    v_mfma_f32_16x16x32_bf16 v[60:63], v[12:15], v[180:183], v[60:63]
    v_and_b32_dpp v8, v32, v4 row_newbcast:7 row_mask:0xf bank_mask:0xf
    v_and_b32_dpp v9, v32, v5 row_newbcast:7 row_mask:0xf bank_mask:0xf
    v_and_b32_dpp v10, v32, v6 row_newbcast:7 row_mask:0xf bank_mask:0xf
    v_and_b32_dpp v11, v32, v7 row_newbcast:7 row_mask:0xf bank_mask:0xf
    s_waitcnt vmcnt(5)
    s_add_u32 s75, s75, s74
    s_cbranch_scc1 L_f66
    s_waitcnt vmcnt(4)
L_f66:
    buffer_load_dwordx4 v[168:171], v22, s[24:27], s60 offen offset:2048 nt
    v_mfma_f32_16x16x32_bf16 v[60:63], v[8:11], v[184:187], v[60:63]
    v_and_b32_dpp v12, v32, v4 row_newbcast:15 row_mask:0xf bank_mask:0xf
    v_and_b32_dpp v13, v32, v5 row_newbcast:15 row_mask:0xf bank_mask:0xf
    v_and_b32_dpp v14, v32, v6 row_newbcast:15 row_mask:0xf bank_mask:0xf
    v_and_b32_dpp v15, v32, v7 row_newbcast:15 row_mask:0xf bank_mask:0xf
    s_waitcnt vmcnt(5)
    s_add_u32 s75, s75, s74
    s_cbranch_scc1 L_f67
    s_waitcnt vmcnt(4)
L_f67:
    buffer_load_dwordx4 v[172:175], v22, s[24:27], s60 offen offset:3072 nt
    s_or_b32 s60, s60, 0x13000
    s_add_u32 s60, s60, 0x4000
    s_and_b32 s60, s60, 0xecfff
    s_add_u32 s63, s63, 1
    s_cmp_lg_u32 s63, s40
    s_cselect_b64 s[24:25], s[24:25], s[28:29]
    s_cselect_b64 s[28:29], s[28:29], s[30:31]
    s_cselect_b64 s[30:31], s[30:31], s[36:37]
    s_cselect_b64 s[36:37], s[36:37], s[42:43]
    s_cselect_b32 s3, 0, s41
    s_cselect_b32 s41, s41, 32
    s_add_u32 s40, s40, s3
    v_mfma_f32_16x16x32_bf16 v[60:63], v[12:15], v[188:191], v[60:63]
    v_and_b32_dpp v8, v33, v4 row_newbcast:0 row_mask:0xf bank_mask:0xf
    v_and_b32_dpp v9, v33, v5 row_newbcast:0 row_mask:0xf bank_mask:0xf
    v_and_b32_dpp v10, v33, v6 row_newbcast:0 row_mask:0xf bank_mask:0xf
    v_and_b32_dpp v11, v33, v7 row_newbcast:0 row_mask:0xf bank_mask:0xf
    v_mov_b32 v32, v33
    v_mov_b32 v33, v34
    v_mov_b32 v34, v35
    v_mov_b32 v35, v36
    v_mov_b32 v36, v37
    v_mov_b32 v37, v38
    v_mov_b32 v38, v39
    s_sub_u32 s73, s73, 1
    s_cmp_lg_u32 s73, 0
    s_cbranch_scc1 L_vB1
    s_mov_b32 s73, 1
L_vB1d:
    s_waitcnt lgkmcnt(0)
    s_add_u32 s39, s39, 16
    v_readfirstlane_b32 s74, v70
    v_mov_b32 v71, s39
    ds_write_b32 v25, v71 offset:4256
    ds_read_b32 v70, v25 offset:4272
    s_waitcnt vmcnt(7)
    buffer_load_dwordx4 v[176:179], v22, s[24:27], s60 offen nt
    v_mfma_f32_16x16x32_bf16 v[60:63], v[8:11], v[128:131], v[60:63]
    v_and_b32_dpp v12, v32, v4 row_newbcast:8 row_mask:0xf bank_mask:0xf
    v_and_b32_dpp v13, v32, v5 row_newbcast:8 row_mask:0xf bank_mask:0xf
    v_and_b32_dpp v14, v32, v6 row_newbcast:8 row_mask:0xf bank_mask:0xf
    v_and_b32_dpp v15, v32, v7 row_newbcast:8 row_mask:0xf bank_mask:0xf
    s_waitcnt vmcnt(7)
    buffer_load_dwordx4 v[180:183], v22, s[24:27], s60 offen offset:1024 nt
    v_mfma_f32_16x16x32_bf16 v[60:63], v[12:15], v[132:135], v[60:63]
    v_and_b32_dpp v8, v32, v4 row_newbcast:4 row_mask:0xf bank_mask:0xf
    v_and_b32_dpp v9, v32, v5 row_newbcast:4 row_mask:0xf bank_mask:0xf
    v_and_b32_dpp v10, v32, v6 row_newbcast:4 row_mask:0xf bank_mask:0xf
    v_and_b32_dpp v11, v32, v7 row_newbcast:4 row_mask:0xf bank_mask:0xf
    s_waitcnt vmcnt(7)
    buffer_load_dwordx4 v[184:187], v22, s[24:27], s60 offen offset:2048 nt
    v_mfma_f32_16x16x32_bf16 v[60:63], v[8:11], v[136:139], v[60:63]
    v_and_b32_dpp v12, v32, v4 row_newbcast:12 row_mask:0xf bank_mask:0xf
    v_and_b32_dpp v13, v32, v5 row_newbcast:12 row_mask:0xf bank_mask:0xf
    v_and_b32_dpp v14, v32, v6 row_newbcast:12 row_mask:0xf bank_mask:0xf
    v_and_b32_dpp v15, v32, v7 row_newbcast:12 row_mask:0xf bank_mask:0xf
    s_waitcnt vmcnt(7)
    buffer_load_dwordx4 v[188:191], v22, s[24:27], s60 offen offset:3072 nt
    s_or_b32 s60, s60, 0x13000
    s_add_u32 s60, s60, 0x4000
    s_and_b32 s60, s60, 0xecfff
    s_add_u32 s63, s63, 1
    s_cmp_lg_u32 s63, s40
    s_cselect_b64 s[24:25], s[24:25], s[28:29]
    s_cselect_b64 s[28:29], s[28:29], s[30:31]
    s_cselect_b64 s[30:31], s[30:31], s[36:37]
    s_cselect_b64 s[36:37], s[36:37], s[42:43]
    s_cselect_b32 s3, 0, s41
    s_cselect_b32 s41, s41, 32
    s_add_u32 s40, s40, s3
    v_mfma_f32_16x16x32_bf16 v[60:63], v[12:15], v[140:143], v[60:63]
    v_and_b32_dpp v8, v32, v4 row_newbcast:2 row_mask:0xf bank_mask:0xf
    v_and_b32_dpp v9, v32, v5 row_newbcast:2 row_mask:0xf bank_mask:0xf
    v_and_b32_dpp v10, v32, v6 row_newbcast:2 row_mask:0xf bank_mask:0xf
    v_and_b32_dpp v11, v32, v7 row_newbcast:2 row_mask:0xf bank_mask:0xf
    s_waitcnt vmcnt(7)
    buffer_load_dwordx4 v[128:131], v22, s[24:27], s60 offen nt
    v_mfma_f32_16x16x32_bf16 v[60:63], v[8:11], v[144:147], v[60:63]
    v_and_b32_dpp v12, v32, v4 row_newbcast:10 row_mask:0xf bank_mask:0xf
    v_and_b32_dpp v13, v32, v5 row_newbcast:10 row_mask:0xf bank_mask:0xf
    v_and_b32_dpp v14, v32, v6 row_newbcast:10 row_mask:0xf bank_mask:0xf
    v_and_b32_dpp v15, v32, v7 row_newbcast:10 row_mask:0xf bank_mask:0xf
    s_waitcnt vmcnt(7)
    buffer_load_dwordx4 v[132:135], v22, s[24:27], s60 offen offset:1024 nt
    v_mfma_f32_16x16x32_bf16 v[60:63], v[12:15], v[148:151], v[60:63]
    v_and_b32_dpp v8, v32, v4 row_newbcast:6 row_mask:0xf bank_mask:0xf
    v_and_b32_dpp v9, v32, v5 row_newbcast:6 row_mask:0xf bank_mask:0xf
    v_and_b32_dpp v10, v32, v6 row_newbcast:6 row_mask:0xf bank_mask:0xf
    v_and_b32_dpp v11, v32, v7 row_newbcast:6 row_mask:0xf bank_mask:0xf
    s_waitcnt vmcnt(7)
    buffer_load_dwordx4 v[136:139], v22, s[24:27], s60 offen offset:2048 nt
    v_mfma_f32_16x16x32_bf16 v[60:63], v[8:11], v[152:155], v[60:63]
    v_and_b32_dpp v12, v32, v4 row_newbcast:14 row_mask:0xf bank_mask:0xf
    v_and_b32_dpp v13, v32, v5 row_newbcast:14 row_mask:0xf bank_mask:0xf
    v_and_b32_dpp v14, v32, v6 row_newbcast:14 row_mask:0xf bank_mask:0xf
    v_and_b32_dpp v15, v32, v7 row_newbcast:14 row_mask:0xf bank_mask:0xf
    s_waitcnt vmcnt(7)
    buffer_load_dwordx4 v[140:143], v22, s[24:27], s60 offen offset:3072 nt
    s_or_b32 s60, s60, 0x13000
    s_add_u32 s60, s60, 0x4000
    s_and_b32 s60, s60, 0xecfff
    s_add_u32 s63, s63, 1
    s_cmp_lg_u32 s63, s40
    s_cselect_b64 s[24:25], s[24:25], s[28:29]
    s_cselect_b64 s[28:29], s[28:29], s[30:31]
    s_cselect_b64 s[30:31], s[30:31], s[36:37]
    s_cselect_b64 s[36:37], s[36:37], s[42:43]
    s_cselect_b32 s3, 0, s41
    s_cselect_b32 s41, s41, 32
    s_add_u32 s40, s40, s3
    v_mfma_f32_16x16x32_bf16 v[60:63], v[12:15], v[156:159], v[60:63]
    v_and_b32_dpp v8, v32, v4 row_newbcast:1 row_mask:0xf bank_mask:0xf
    v_and_b32_dpp v9, v32, v5 row_newbcast:1 row_mask:0xf bank_mask:0xf
    v_and_b32_dpp v10, v32, v6 row_newbcast:1 row_mask:0xf bank_mask:0xf
    v_and_b32_dpp v11, v32, v7 row_newbcast:1 row_mask:0xf bank_mask:0xf
    s_waitcnt vmcnt(7)
    buffer_load_dwordx4 v[144:147], v22, s[24:27], s60 offen nt
    v_mfma_f32_16x16x32_bf16 v[60:63], v[8:11], v[160:163], v[60:63]
    v_and_b32_dpp v12, v32, v4 row_newbcast:9 row_mask:0xf bank_mask:0xf
    v_and_b32_dpp v13, v32, v5 row_newbcast:9 row_mask:0xf bank_mask:0xf
    v_and_b32_dpp v14, v32, v6 row_newbcast:9 row_mask:0xf bank_mask:0xf
    v_and_b32_dpp v15, v32, v7 row_newbcast:9 row_mask:0xf bank_mask:0xf
    s_waitcnt vmcnt(7)
    buffer_load_dwordx4 v[148:151], v22, s[24:27], s60 offen offset:1024 nt
    v_mfma_f32_16x16x32_bf16 v[60:63], v[12:15], v[164:167], v[60:63]
    v_and_b32_dpp v8, v32, v4 row_newbcast:5 row_mask:0xf bank_mask:0xf
    v_and_b32_dpp v9, v32, v5 row_newbcast:5 row_mask:0xf bank_mask:0xf
    v_and_b32_dpp v10, v32, v6 row_newbcast:5 row_mask:0xf bank_mask:0xf
    v_and_b32_dpp v11, v32, v7 row_newbcast:5 row_mask:0xf bank_mask:0xf
    s_waitcnt vmcnt(7)
    buffer_load_dwordx4 v[152:155], v22, s[24:27], s60 offen offset:2048 nt
    v_mfma_f32_16x16x32_bf16 v[60:63], v[8:11], v[168:171], v[60:63]
    v_and_b32_dpp v12, v32, v4 row_newbcast:13 row_mask:0xf bank_mask:0xf
    v_and_b32_dpp v13, v32, v5 row_newbcast:13 row_mask:0xf bank_mask:0xf
    v_and_b32_dpp v14, v32, v6 row_newbcast:13 row_mask:0xf bank_mask:0xf
    v_and_b32_dpp v15, v32, v7 row_newbcast:13 row_mask:0xf bank_mask:0xf
    s_waitcnt vmcnt(7)
    buffer_load_dwordx4 v[156:159], v22, s[24:27], s60 offen offset:3072 nt
    s_or_b32 s60, s60, 0x13000
    s_add_u32 s60, s60, 0x4000
    s_and_b32 s60, s60, 0xecfff
    s_add_u32 s63, s63, 1
    s_cmp_lg_u32 s63, s40
    s_cselect_b64 s[24:25], s[24:25], s[28:29]
    s_cselect_b64 s[28:29], s[28:29], s[30:31]
    s_cselect_b64 s[30:31], s[30:31], s[36:37]
    s_cselect_b64 s[36:37], s[36:37], s[42:43]
    s_cselect_b32 s3, 0, s41
    s_cselect_b32 s41, s41, 32
    s_add_u32 s40, s40, s3
    v_mfma_f32_16x16x32_bf16 v[60:63], v[12:15], v[172:175], v[60:63]
    v_and_b32_dpp v8, v32, v4 row_newbcast:3 row_mask:0xf bank_mask:0xf
    v_and_b32_dpp v9, v32, v5 row_newbcast:3 row_mask:0xf bank_mask:0xf
    v_and_b32_dpp v10, v32, v6 row_newbcast:3 row_mask:0xf bank_mask:0xf
    v_and_b32_dpp v11, v32, v7 row_newbcast:3 row_mask:0xf bank_mask:0xf
    s_waitcnt vmcnt(7)
    buffer_load_dwordx4 v[160:163], v22, s[24:27], s60 offen nt
    v_mfma_f32_16x16x32_bf16 v[60:63], v[8:11], v[176:179], v[60:63]
    v_and_b32_dpp v12, v32, v4 row_newbcast:11 row_mask:0xf bank_mask:0xf
    v_and_b32_dpp v13, v32, v5 row_newbcast:11 row_mask:0xf bank_mask:0xf
    v_and_b32_dpp v14, v32, v6 row_newbcast:11 row_mask:0xf bank_mask:0xf
    v_and_b32_dpp v15, v32, v7 row_newbcast:11 row_mask:0xf bank_mask:0xf
    s_waitcnt vmcnt(7)
    buffer_load_dwordx4 v[164:167], v22, s[24:27], s60 offen offset:1024 nt
    v_mfma_f32_16x16x32_bf16 v[60:63], v[12:15], v[180:183], v[60:63]
    v_and_b32_dpp v8, v32, v4 row_newbcast:7 row_mask:0xf bank_mask:0xf
    v_and_b32_dpp v9, v32, v5 row_newbcast:7 row_mask:0xf bank_mask:0xf
    v_and_b32_dpp v10, v32, v6 row_newbcast:7 row_mask:0xf bank_mask:0xf
    v_and_b32_dpp v11, v32, v7 row_newbcast:7 row_mask:0xf bank_mask:0xf
    s_waitcnt vmcnt(7)
    buffer_load_dwordx4 v[168:171], v22, s[24:27], s60 offen offset:2048 nt
    v_mfma_f32_16x16x32_bf16 v[60:63], v[8:11], v[184:187], v[60:63]
    v_and_b32_dpp v12, v32, v4 row_newbcast:15 row_mask:0xf bank_mask:0xf
    v_and_b32_dpp v13, v32, v5 row_newbcast:15 row_mask:0xf bank_mask:0xf
    v_and_b32_dpp v14, v32, v6 row_newbcast:15 row_mask:0xf bank_mask:0xf
    v_and_b32_dpp v15, v32, v7 row_newbcast:15 row_mask:0xf bank_mask:0xf
    s_waitcnt vmcnt(7)
    buffer_load_dwordx4 v[172:175], v22, s[24:27], s60 offen offset:3072 nt
    s_or_b32 s60, s60, 0x13000
    s_add_u32 s60, s60, 0x4000
    s_and_b32 s60, s60, 0xecfff
    s_add_u32 s63, s63, 1
    s_cmp_lg_u32 s63, s40
    s_cselect_b64 s[24:25], s[24:25], s[28:29]
    s_cselect_b64 s[28:29], s[28:29], s[30:31]
    s_cselect_b64 s[30:31], s[30:31], s[36:37]
    s_cselect_b64 s[36:37], s[36:37], s[42:43]
    s_cselect_b32 s3, 0, s41
    s_cselect_b32 s41, s41, 32
    s_add_u32 s40, s40, s3
    v_mfma_f32_16x16x32_bf16 v[60:63], v[12:15], v[188:191], v[60:63]
    v_and_b32_dpp v8, v33, v4 row_newbcast:0 row_mask:0xf bank_mask:0xf
    v_and_b32_dpp v9, v33, v5 row_newbcast:0 row_mask:0xf bank_mask:0xf
    v_and_b32_dpp v10, v33, v6 row_newbcast:0 row_mask:0xf bank_mask:0xf
    v_and_b32_dpp v11, v33, v7 row_newbcast:0 row_mask:0xf bank_mask:0xf
    v_mov_b32 v32, v33
    v_mov_b32 v33, v34
    v_mov_b32 v34, v35
    v_mov_b32 v35, v36
    v_mov_b32 v36, v37
    v_mov_b32 v37, v38
    v_mov_b32 v38, v39
    s_sub_u32 s73, s73, 1
    s_cmp_lg_u32 s73, 0
    s_cbranch_scc1 L_vB1d
    s_mov_b64 exec, 1
    ds_add_u32 v24, v23 offset:4236
    s_mov_b64 exec, -1
    s_waitcnt vmcnt(7)
    buffer_load_dwordx4 v[176:179], v22, s[24:27], s60 offen nt
    s_mov_b32 s70, 0
L_m68:
    ds_read_b128 v[40:43], v24 offset:4160
    ds_read_b128 v[44:47], v24 offset:4176
    s_add_u32 s70, s70, 1
    s_waitcnt lgkmcnt(0)
    v_min3_u32 v18, v41, v43, v45
    v_min3_u32 v18, v18, v47, v47
    s_cmp_ge_u32 s70, 0x100000
    v_readfirstlane_b32 s3, v18
    s_cbranch_scc1 L_m68_ok
    s_cmp_lg_u32 s3, 0
    s_cbranch_scc0 L_m68
L_m68_ok:
    s_waitcnt vmcnt(7)
    buffer_load_dwordx4 v[180:183], v22, s[24:27], s60 offen offset:1024 nt
    v_max3_f32 v17, v40, v42, v44
    v_max_f32 v17, v17, v46
    v_sub_f32 v20, v20, v17
    v_exp_f32 v20, v20
    s_waitcnt lgkmcnt(0)
    s_add_u32 s39, s39, 16
    v_readfirstlane_b32 s74, v70
    v_mov_b32 v71, s39
    ds_write_b32 v25, v71 offset:4256
    ds_read_b32 v70, v25 offset:4272
    s_waitcnt vmcnt(7)
    buffer_load_dwordx4 v[184:187], v22, s[24:27], s60 offen offset:2048 nt
    v_mfma_f32_16x16x32_bf16 v[60:63], v[8:11], v[128:131], v[60:63]
    v_and_b32_dpp v12, v32, v4 row_newbcast:8 row_mask:0xf bank_mask:0xf
    v_and_b32_dpp v13, v32, v5 row_newbcast:8 row_mask:0xf bank_mask:0xf
    v_and_b32_dpp v14, v32, v6 row_newbcast:8 row_mask:0xf bank_mask:0xf
    v_and_b32_dpp v15, v32, v7 row_newbcast:8 row_mask:0xf bank_mask:0xf
    s_waitcnt vmcnt(7)
    buffer_load_dwordx4 v[188:191], v22, s[24:27], s60 offen offset:3072 nt
    s_or_b32 s60, s60, 0x13000
    s_add_u32 s60, s60, 0x4000
    s_and_b32 s60, s60, 0xecfff
    s_add_u32 s63, s63, 1
    s_cmp_lg_u32 s63, s40
    s_cselect_b64 s[24:25], s[24:25], s[28:29]
    s_cselect_b64 s[28:29], s[28:29], s[30:31]
    s_cselect_b64 s[30:31], s[30:31], s[36:37]
    s_cselect_b64 s[36:37], s[36:37], s[42:43]
    s_cselect_b32 s3, 0, s41
    s_cselect_b32 s41, s41, 32
    s_add_u32 s40, s40, s3
    v_mfma_f32_16x16x32_bf16 v[60:63], v[12:15], v[132:135], v[60:63]
    v_and_b32_dpp v8, v32, v4 row_newbcast:4 row_mask:0xf bank_mask:0xf
    v_and_b32_dpp v9, v32, v5 row_newbcast:4 row_mask:0xf bank_mask:0xf
    v_and_b32_dpp v10, v32, v6 row_newbcast:4 row_mask:0xf bank_mask:0xf
    v_and_b32_dpp v11, v32, v7 row_newbcast:4 row_mask:0xf bank_mask:0xf
    s_nop 1
    v_mfma_f32_16x16x32_bf16 v[60:63], v[8:11], v[136:139], v[60:63]
    v_and_b32_dpp v12, v32, v4 row_newbcast:12 row_mask:0xf bank_mask:0xf
    v_and_b32_dpp v13, v32, v5 row_newbcast:12 row_mask:0xf bank_mask:0xf
    v_and_b32_dpp v14, v32, v6 row_newbcast:12 row_mask:0xf bank_mask:0xf
    v_and_b32_dpp v15, v32, v7 row_newbcast:12 row_mask:0xf bank_mask:0xf
    s_nop 1
    v_mfma_f32_16x16x32_bf16 v[60:63], v[12:15], v[140:143], v[60:63]
    v_and_b32_dpp v8, v32, v4 row_newbcast:2 row_mask:0xf bank_mask:0xf
    v_and_b32_dpp v9, v32, v5 row_newbcast:2 row_mask:0xf bank_mask:0xf
    v_and_b32_dpp v10, v32, v6 row_newbcast:2 row_mask:0xf bank_mask:0xf
    v_and_b32_dpp v11, v32, v7 row_newbcast:2 row_mask:0xf bank_mask:0xf
    s_nop 1
    v_mfma_f32_16x16x32_bf16 v[60:63], v[8:11], v[144:147], v[60:63]
    v_and_b32_dpp v12, v32, v4 row_newbcast:10 row_mask:0xf bank_mask:0xf
    v_and_b32_dpp v13, v32, v5 row_newbcast:10 row_mask:0xf bank_mask:0xf
    v_and_b32_dpp v14, v32, v6 row_newbcast:10 row_mask:0xf bank_mask:0xf
    v_and_b32_dpp v15, v32, v7 row_newbcast:10 row_mask:0xf bank_mask:0xf
    s_nop 1
    v_mfma_f32_16x16x32_bf16 v[60:63], v[12:15], v[148:151], v[60:63]
    v_and_b32_dpp v8, v32, v4 row_newbcast:6 row_mask:0xf bank_mask:0xf
    v_and_b32_dpp v9, v32, v5 row_newbcast:6 row_mask:0xf bank_mask:0xf
    v_and_b32_dpp v10, v32, v6 row_newbcast:6 row_mask:0xf bank_mask:0xf
    v_and_b32_dpp v11, v32, v7 row_newbcast:6 row_mask:0xf bank_mask:0xf
    s_nop 1
    v_mfma_f32_16x16x32_bf16 v[60:63], v[8:11], v[152:155], v[60:63]
    v_and_b32_dpp v12, v32, v4 row_newbcast:14 row_mask:0xf bank_mask:0xf
    v_and_b32_dpp v13, v32, v5 row_newbcast:14 row_mask:0xf bank_mask:0xf
    v_and_b32_dpp v14, v32, v6 row_newbcast:14 row_mask:0xf bank_mask:0xf
    v_and_b32_dpp v15, v32, v7 row_newbcast:14 row_mask:0xf bank_mask:0xf
    s_nop 1
    v_mfma_f32_16x16x32_bf16 v[60:63], v[12:15], v[156:159], v[60:63]
    v_and_b32_dpp v8, v32, v4 row_newbcast:1 row_mask:0xf bank_mask:0xf
    v_and_b32_dpp v9, v32, v5 row_newbcast:1 row_mask:0xf bank_mask:0xf
    v_and_b32_dpp v10, v32, v6 row_newbcast:1 row_mask:0xf bank_mask:0xf
    v_and_b32_dpp v11, v32, v7 row_newbcast:1 row_mask:0xf bank_mask:0xf
    s_waitcnt vmcnt(7)
    s_nop 0
    v_mfma_f32_16x16x32_bf16 v[60:63], v[8:11], v[160:163], v[60:63]
    v_and_b32_dpp v12, v32, v4 row_newbcast:9 row_mask:0xf bank_mask:0xf
    v_and_b32_dpp v13, v32, v5 row_newbcast:9 row_mask:0xf bank_mask:0xf
    v_and_b32_dpp v14, v32, v6 row_newbcast:9 row_mask:0xf bank_mask:0xf
    v_and_b32_dpp v15, v32, v7 row_newbcast:9 row_mask:0xf bank_mask:0xf
    s_waitcnt vmcnt(6)
    s_nop 0
    v_mfma_f32_16x16x32_bf16 v[60:63], v[12:15], v[164:167], v[60:63]
    v_and_b32_dpp v8, v32, v4 row_newbcast:5 row_mask:0xf bank_mask:0xf
    v_and_b32_dpp v9, v32, v5 row_newbcast:5 row_mask:0xf bank_mask:0xf
    v_and_b32_dpp v10, v32, v6 row_newbcast:5 row_mask:0xf bank_mask:0xf
    v_and_b32_dpp v11, v32, v7 row_newbcast:5 row_mask:0xf bank_mask:0xf
    s_waitcnt vmcnt(5)
    s_nop 0
    v_mfma_f32_16x16x32_bf16 v[60:63], v[8:11], v[168:171], v[60:63]
    v_and_b32_dpp v12, v32, v4 row_newbcast:13 row_mask:0xf bank_mask:0xf
    v_and_b32_dpp v13, v32, v5 row_newbcast:13 row_mask:0xf bank_mask:0xf
    v_and_b32_dpp v14, v32, v6 row_newbcast:13 row_mask:0xf bank_mask:0xf
    v_and_b32_dpp v15, v32, v7 row_newbcast:13 row_mask:0xf bank_mask:0xf
    s_waitcnt vmcnt(4)
    s_nop 0
    v_mfma_f32_16x16x32_bf16 v[60:63], v[12:15], v[172:175], v[60:63]
    v_and_b32_dpp v8, v32, v4 row_newbcast:3 row_mask:0xf bank_mask:0xf
    v_and_b32_dpp v9, v32, v5 row_newbcast:3 row_mask:0xf bank_mask:0xf
    v_and_b32_dpp v10, v32, v6 row_newbcast:3 row_mask:0xf bank_mask:0xf
    v_and_b32_dpp v11, v32, v7 row_newbcast:3 row_mask:0xf bank_mask:0xf
    s_waitcnt vmcnt(3)
    s_nop 0
    v_mfma_f32_16x16x32_bf16 v[60:63], v[8:11], v[176:179], v[60:63]
    v_and_b32_dpp v12, v32, v4 row_newbcast:11 row_mask:0xf bank_mask:0xf
    v_and_b32_dpp v13, v32, v5 row_newbcast:11 row_mask:0xf bank_mask:0xf
    v_and_b32_dpp v14, v32, v6 row_newbcast:11 row_mask:0xf bank_mask:0xf
    v_and_b32_dpp v15, v32, v7 row_newbcast:11 row_mask:0xf bank_mask:0xf
    s_waitcnt vmcnt(2)
    s_nop 0
    v_mfma_f32_16x16x32_bf16 v[60:63], v[12:15], v[180:183], v[60:63]
    v_and_b32_dpp v8, v32, v4 row_newbcast:7 row_mask:0xf bank_mask:0xf
    v_and_b32_dpp v9, v32, v5 row_newbcast:7 row_mask:0xf bank_mask:0xf
    v_and_b32_dpp v10, v32, v6 row_newbcast:7 row_mask:0xf bank_mask:0xf
    v_and_b32_dpp v11, v32, v7 row_newbcast:7 row_mask:0xf bank_mask:0xf
    s_waitcnt vmcnt(1)
    s_nop 0
    v_mfma_f32_16x16x32_bf16 v[60:63], v[8:11], v[184:187], v[60:63]
    v_and_b32_dpp v12, v32, v4 row_newbcast:15 row_mask:0xf bank_mask:0xf
    v_and_b32_dpp v13, v32, v5 row_newbcast:15 row_mask:0xf bank_mask:0xf
    v_and_b32_dpp v14, v32, v6 row_newbcast:15 row_mask:0xf bank_mask:0xf
    v_and_b32_dpp v15, v32, v7 row_newbcast:15 row_mask:0xf bank_mask:0xf
    s_waitcnt vmcnt(0)
    s_nop 0
    v_mfma_f32_16x16x32_bf16 v[60:63], v[12:15], v[188:191], v[60:63]
    s_nop 7
    s_branch L_last
L_half0:
    s_waitcnt lgkmcnt(0)
    s_add_u32 s39, s39, 16
    v_readfirstlane_b32 s74, v70
    v_mov_b32 v71, s39
    ds_write_b32 v25, v71 offset:4256
    ds_read_b32 v70, v25 offset:4272
    s_waitcnt vmcnt(4)
    buffer_load_dwordx4 v[176:179], v22, s[24:27], s60 offen nt
    v_mfma_f32_16x16x32_bf16 v[60:63], v[8:11], v[128:131], v[60:63]
    v_and_b32_dpp v12, v32, v4 row_newbcast:8 row_mask:0xf bank_mask:0xf
    v_and_b32_dpp v13, v32, v5 row_newbcast:8 row_mask:0xf bank_mask:0xf
    v_and_b32_dpp v14, v32, v6 row_newbcast:8 row_mask:0xf bank_mask:0xf
    v_and_b32_dpp v15, v32, v7 row_newbcast:8 row_mask:0xf bank_mask:0xf
    s_waitcnt vmcnt(4)
    buffer_load_dwordx4 v[180:183], v22, s[24:27], s60 offen offset:1024 nt
    v_mfma_f32_16x16x32_bf16 v[60:63], v[12:15], v[132:135], v[60:63]
    v_and_b32_dpp v8, v32, v4 row_newbcast:4 row_mask:0xf bank_mask:0xf
    v_and_b32_dpp v9, v32, v5 row_newbcast:4 row_mask:0xf bank_mask:0xf
    v_and_b32_dpp v10, v32, v6 row_newbcast:4 row_mask:0xf bank_mask:0xf
    v_and_b32_dpp v11, v32, v7 row_newbcast:4 row_mask:0xf bank_mask:0xf
    s_nop 1
    v_mfma_f32_16x16x32_bf16 v[60:63], v[8:11], v[136:139], v[60:63]
    v_and_b32_dpp v12, v32, v4 row_newbcast:12 row_mask:0xf bank_mask:0xf
    v_and_b32_dpp v13, v32, v5 row_newbcast:12 row_mask:0xf bank_mask:0xf
    v_and_b32_dpp v14, v32, v6 row_newbcast:12 row_mask:0xf bank_mask:0xf
    v_and_b32_dpp v15, v32, v7 row_newbcast:12 row_mask:0xf bank_mask:0xf
    s_waitcnt vmcnt(4)
    buffer_load_dwordx4 v[184:187], v22, s[24:27], s60 offen offset:2048 nt
    v_mfma_f32_16x16x32_bf16 v[60:63], v[12:15], v[140:143], v[60:63]
    v_and_b32_dpp v8, v32, v4 row_newbcast:2 row_mask:0xf bank_mask:0xf
    v_and_b32_dpp v9, v32, v5 row_newbcast:2 row_mask:0xf bank_mask:0xf
    v_and_b32_dpp v10, v32, v6 row_newbcast:2 row_mask:0xf bank_mask:0xf
    v_and_b32_dpp v11, v32, v7 row_newbcast:2 row_mask:0xf bank_mask:0xf
    s_waitcnt vmcnt(4)
    buffer_load_dwordx4 v[188:191], v22, s[24:27], s60 offen offset:3072 nt
    s_or_b32 s60, s60, 0x13000
    s_add_u32 s60, s60, 0x4000
    s_and_b32 s60, s60, 0xecfff
    s_add_u32 s63, s63, 1
    s_cmp_lg_u32 s63, s40
    s_cselect_b64 s[24:25], s[24:25], s[28:29]
    s_cselect_b64 s[28:29], s[28:29], s[30:31]
    s_cselect_b64 s[30:31], s[30:31], s[36:37]
    s_cselect_b64 s[36:37], s[36:37], s[42:43]
    s_cselect_b32 s3, 0, s41
    s_cselect_b32 s41, s41, 32
    s_add_u32 s40, s40, s3
    v_mfma_f32_16x16x32_bf16 v[60:63], v[8:11], v[144:147], v[60:63]
    v_and_b32_dpp v12, v32, v4 row_newbcast:10 row_mask:0xf bank_mask:0xf
    v_and_b32_dpp v13, v32, v5 row_newbcast:10 row_mask:0xf bank_mask:0xf
    v_and_b32_dpp v14, v32, v6 row_newbcast:10 row_mask:0xf bank_mask:0xf
    v_and_b32_dpp v15, v32, v7 row_newbcast:10 row_mask:0xf bank_mask:0xf
    s_nop 1
    v_mfma_f32_16x16x32_bf16 v[60:63], v[12:15], v[148:151], v[60:63]
    v_and_b32_dpp v8, v32, v4 row_newbcast:6 row_mask:0xf bank_mask:0xf
    v_and_b32_dpp v9, v32, v5 row_newbcast:6 row_mask:0xf bank_mask:0xf
    v_and_b32_dpp v10, v32, v6 row_newbcast:6 row_mask:0xf bank_mask:0xf
    v_and_b32_dpp v11, v32, v7 row_newbcast:6 row_mask:0xf bank_mask:0xf
    s_waitcnt vmcnt(4)
    buffer_load_dwordx4 v[128:131], v22, s[24:27], s60 offen nt
    v_mfma_f32_16x16x32_bf16 v[60:63], v[8:11], v[152:155], v[60:63]
    v_and_b32_dpp v12, v32, v4 row_newbcast:14 row_mask:0xf bank_mask:0xf
    v_and_b32_dpp v13, v32, v5 row_newbcast:14 row_mask:0xf bank_mask:0xf
    v_and_b32_dpp v14, v32, v6 row_newbcast:14 row_mask:0xf bank_mask:0xf
    v_and_b32_dpp v15, v32, v7 row_newbcast:14 row_mask:0xf bank_mask:0xf
    s_waitcnt vmcnt(4)
    buffer_load_dwordx4 v[132:135], v22, s[24:27], s60 offen offset:1024 nt
    v_mfma_f32_16x16x32_bf16 v[60:63], v[12:15], v[156:159], v[60:63]
    v_and_b32_dpp v8, v32, v4 row_newbcast:1 row_mask:0xf bank_mask:0xf
    v_and_b32_dpp v9, v32, v5 row_newbcast:1 row_mask:0xf bank_mask:0xf
    v_and_b32_dpp v10, v32, v6 row_newbcast:1 row_mask:0xf bank_mask:0xf
    v_and_b32_dpp v11, v32, v7 row_newbcast:1 row_mask:0xf bank_mask:0xf
    s_nop 1
    v_mfma_f32_16x16x32_bf16 v[60:63], v[8:11], v[160:163], v[60:63]
    v_and_b32_dpp v12, v32, v4 row_newbcast:9 row_mask:0xf bank_mask:0xf
    v_and_b32_dpp v13, v32, v5 row_newbcast:9 row_mask:0xf bank_mask:0xf
    v_and_b32_dpp v14, v32, v6 row_newbcast:9 row_mask:0xf bank_mask:0xf
    v_and_b32_dpp v15, v32, v7 row_newbcast:9 row_mask:0xf bank_mask:0xf
    s_waitcnt vmcnt(4)
    buffer_load_dwordx4 v[136:139], v22, s[24:27], s60 offen offset:2048 nt
    v_mfma_f32_16x16x32_bf16 v[60:63], v[12:15], v[164:167], v[60:63]
    v_and_b32_dpp v8, v32, v4 row_newbcast:5 row_mask:0xf bank_mask:0xf
    v_and_b32_dpp v9, v32, v5 row_newbcast:5 row_mask:0xf bank_mask:0xf
    v_and_b32_dpp v10, v32, v6 row_newbcast:5 row_mask:0xf bank_mask:0xf
    v_and_b32_dpp v11, v32, v7 row_newbcast:5 row_mask:0xf bank_mask:0xf
    s_nop 1
    v_mfma_f32_16x16x32_bf16 v[60:63], v[8:11], v[168:171], v[60:63]
    v_and_b32_dpp v12, v32, v4 row_newbcast:13 row_mask:0xf bank_mask:0xf
    v_and_b32_dpp v13, v32, v5 row_newbcast:13 row_mask:0xf bank_mask:0xf
    v_and_b32_dpp v14, v32, v6 row_newbcast:13 row_mask:0xf bank_mask:0xf
    v_and_b32_dpp v15, v32, v7 row_newbcast:13 row_mask:0xf bank_mask:0xf
    s_waitcnt vmcnt(4)
    buffer_load_dwordx4 v[140:143], v22, s[24:27], s60 offen offset:3072 nt
    s_or_b32 s60, s60, 0x13000
    s_add_u32 s60, s60, 0x4000
    s_and_b32 s60, s60, 0xecfff
    s_add_u32 s63, s63, 1
    s_cmp_lg_u32 s63, s40
    s_cselect_b64 s[24:25], s[24:25], s[28:29]
    s_cselect_b64 s[28:29], s[28:29], s[30:31]
    s_cselect_b64 s[30:31], s[30:31], s[36:37]
    s_cselect_b64 s[36:37], s[36:37], s[42:43]
    s_cselect_b32 s3, 0, s41
    s_cselect_b32 s41, s41, 32
    s_add_u32 s40, s40, s3
    v_mfma_f32_16x16x32_bf16 v[60:63], v[12:15], v[172:175], v[60:63]
    v_and_b32_dpp v8, v32, v4 row_newbcast:3 row_mask:0xf bank_mask:0xf
    v_and_b32_dpp v9, v32, v5 row_newbcast:3 row_mask:0xf bank_mask:0xf
    v_and_b32_dpp v10, v32, v6 row_newbcast:3 row_mask:0xf bank_mask:0xf
    v_and_b32_dpp v11, v32, v7 row_newbcast:3 row_mask:0xf bank_mask:0xf
    s_nop 1
    v_mfma_f32_16x16x32_bf16 v[60:63], v[8:11], v[176:179], v[60:63]
    v_and_b32_dpp v12, v32, v4 row_newbcast:11 row_mask:0xf bank_mask:0xf
    v_and_b32_dpp v13, v32, v5 row_newbcast:11 row_mask:0xf bank_mask:0xf
    v_and_b32_dpp v14, v32, v6 row_newbcast:11 row_mask:0xf bank_mask:0xf
    v_and_b32_dpp v15, v32, v7 row_newbcast:11 row_mask:0xf bank_mask:0xf
    s_waitcnt vmcnt(4)
    buffer_load_dwordx4 v[144:147], v22, s[24:27], s60 offen nt
    v_mfma_f32_16x16x32_bf16 v[60:63], v[12:15], v[180:183], v[60:63]
    v_and_b32_dpp v8, v32, v4 row_newbcast:7 row_mask:0xf bank_mask:0xf
    v_and_b32_dpp v9, v32, v5 row_newbcast:7 row_mask:0xf bank_mask:0xf
    v_and_b32_dpp v10, v32, v6 row_newbcast:7 row_mask:0xf bank_mask:0xf
    v_and_b32_dpp v11, v32, v7 row_newbcast:7 row_mask:0xf bank_mask:0xf
    s_nop 1
    v_mfma_f32_16x16x32_bf16 v[60:63], v[8:11], v[184:187], v[60:63]
    v_and_b32_dpp v12, v32, v4 row_newbcast:15 row_mask:0xf bank_mask:0xf
    v_and_b32_dpp v13, v32, v5 row_newbcast:15 row_mask:0xf bank_mask:0xf
    v_and_b32_dpp v14, v32, v6 row_newbcast:15 row_mask:0xf bank_mask:0xf
    v_and_b32_dpp v15, v32, v7 row_newbcast:15 row_mask:0xf bank_mask:0xf
    s_waitcnt vmcnt(4)
    buffer_load_dwordx4 v[148:151], v22, s[24:27], s60 offen offset:1024 nt
    v_mfma_f32_16x16x32_bf16 v[60:63], v[12:15], v[188:191], v[60:63]
    v_mov_b32 v68, v33
    v_mov_b32 v69, v20
    s_nop 5
    v_mov_b32 v64, v60
    v_mov_b32 v65, v61
    v_mov_b32 v66, v62
    v_mov_b32 v67, v63
    s_mov_b32 s70, 0
L_w69:
    ds_read_b32 v19, v24 offset:4228
    s_add_u32 s70, s70, 1
    s_waitcnt lgkmcnt(0)
    v_readfirstlane_b32 s3, v19
    s_cmp_ge_u32 s70, 0x100000
    s_cbranch_scc1 L_w69_ok
    s_cmp_ge_u32 s3, 1
    s_cbranch_scc0 L_w69
L_w69_ok:
    v_lshlrev_b32 v17, 5, v3
    ds_read_b128 v[32:35], v17 offset:15872
    ds_read_b128 v[36:39], v17 offset:15888
    s_waitcnt vmcnt(4)
    buffer_load_dwordx4 v[152:155], v22, s[24:27], s60 offen offset:2048 nt
    s_waitcnt vmcnt(4)
    buffer_load_dwordx4 v[156:159], v22, s[24:27], s60 offen offset:3072 nt
    s_or_b32 s60, s60, 0x13000
    s_add_u32 s60, s60, 0x4000
    s_and_b32 s60, s60, 0xecfff
    s_add_u32 s63, s63, 1
    s_cmp_lg_u32 s63, s40
    s_cselect_b64 s[24:25], s[24:25], s[28:29]
    s_cselect_b64 s[28:29], s[28:29], s[30:31]
    s_cselect_b64 s[30:31], s[30:31], s[36:37]
    s_cselect_b64 s[36:37], s[36:37], s[42:43]
    s_cselect_b32 s3, 0, s41
    s_cselect_b32 s41, s41, 32
    s_add_u32 s40, s40, s3
    s_waitcnt lgkmcnt(0)
    v_cvt_pk_bf16_f32 v28, v32, v33
    v_cvt_pk_bf16_f32 v29, v34, v35
    v_cvt_pk_bf16_f32 v30, v36, v37
    v_cvt_pk_bf16_f32 v31, v38, v39
    s_mov_b32 s73, 8
    s_nop 0
L_kB0:
    s_waitcnt lgkmcnt(0)
    s_add_u32 s39, s39, 4
    v_readfirstlane_b32 s74, v70
    v_mov_b32 v71, s39
    ds_write_b32 v25, v71 offset:4256
    ds_read_b32 v70, v25 offset:4272
    s_waitcnt vmcnt(5)
    s_add_u32 s75, s75, s74
    s_cbranch_scc1 L_f70
    s_waitcnt vmcnt(4)
L_f70:
    buffer_load_dwordx4 v[160:163], v22, s[24:27], s60 offen nt
    v_dot2_f32_bf16 v48, v128, v28, 0
    v_dot2_f32_bf16 v48, v129, v29, v48
    v_dot2_f32_bf16 v48, v130, v30, v48
    v_dot2_f32_bf16 v48, v131, v31, v48
    v_add_f32_dpp v53, v50, v50 row_ror:8 row_mask:0xf bank_mask:0x3
    v_add_f32_dpp v53, v51, v51 row_ror:8 row_mask:0xf bank_mask:0xc
    s_waitcnt vmcnt(5)
    s_add_u32 s75, s75, s74
    s_cbranch_scc1 L_f71
    s_waitcnt vmcnt(4)
L_f71:
    buffer_load_dwordx4 v[164:167], v22, s[24:27], s60 offen offset:1024 nt
    v_dot2_f32_bf16 v49, v132, v28, 0
    v_dot2_f32_bf16 v49, v133, v29, v49
    v_dot2_f32_bf16 v49, v134, v30, v49
    v_dot2_f32_bf16 v49, v135, v31, v49
    v_add_f32_dpp v55, v52, v52 row_half_mirror row_mask:0xf bank_mask:0x5
    v_add_f32_dpp v55, v53, v53 row_half_mirror row_mask:0xf bank_mask:0xa
    s_waitcnt vmcnt(5)
    s_add_u32 s75, s75, s74
    s_cbranch_scc1 L_f72
    s_waitcnt vmcnt(4)
L_f72:
    buffer_load_dwordx4 v[168:171], v22, s[24:27], s60 offen offset:2048 nt
    v_dot2_f32_bf16 v50, v136, v28, 0
    v_dot2_f32_bf16 v50, v137, v29, v50
    v_dot2_f32_bf16 v50, v138, v30, v50
    v_dot2_f32_bf16 v50, v139, v31, v50
    v_add_f32_dpp v58, v54, v54 quad_perm:[2,3,0,1] row_mask:0xf bank_mask:0xf
    v_add_f32_dpp v59, v55, v55 quad_perm:[2,3,0,1] row_mask:0xf bank_mask:0xf
    v_cndmask_b32_e64 v57, v58, v59, s[64:65]
    s_waitcnt vmcnt(5)
    s_add_u32 s75, s75, s74
    s_cbranch_scc1 L_f73
    s_waitcnt vmcnt(4)
L_f73:
    buffer_load_dwordx4 v[172:175], v22, s[24:27], s60 offen offset:3072 nt
    s_or_b32 s60, s60, 0x13000
    s_add_u32 s60, s60, 0x4000
    s_and_b32 s60, s60, 0xecfff
    s_add_u32 s63, s63, 1
    s_cmp_lg_u32 s63, s40
    s_cselect_b64 s[24:25], s[24:25], s[28:29]
    s_cselect_b64 s[28:29], s[28:29], s[30:31]
    s_cselect_b64 s[30:31], s[30:31], s[36:37]
    s_cselect_b64 s[36:37], s[36:37], s[42:43]
    s_cselect_b32 s3, 0, s41
    s_cselect_b32 s41, s41, 32
    s_add_u32 s40, s40, s3
    v_dot2_f32_bf16 v51, v140, v28, 0
    v_dot2_f32_bf16 v51, v141, v29, v51
    v_dot2_f32_bf16 v51, v142, v30, v51
    v_dot2_f32_bf16 v51, v143, v31, v51
    v_add_f32_dpp v52, v48, v48 row_ror:8 row_mask:0xf bank_mask:0x3
    v_add_f32_dpp v52, v49, v49 row_ror:8 row_mask:0xf bank_mask:0xc
    s_waitcnt lgkmcnt(0)
    s_add_u32 s39, s39, 4
    v_readfirstlane_b32 s74, v70
    v_mov_b32 v71, s39
    ds_write_b32 v25, v71 offset:4256
    ds_read_b32 v70, v25 offset:4272
    s_waitcnt vmcnt(5)
    s_add_u32 s75, s75, s74
    s_cbranch_scc1 L_f74
    s_waitcnt vmcnt(4)
L_f74:
    buffer_load_dwordx4 v[176:179], v22, s[24:27], s60 offen nt
    v_dot2_f32_bf16 v48, v144, v28, 0
    v_dot2_f32_bf16 v48, v145, v29, v48
    v_dot2_f32_bf16 v48, v146, v30, v48
    v_dot2_f32_bf16 v48, v147, v31, v48
    v_add_f32_dpp v58, v56, v56 quad_perm:[1,0,3,2] row_mask:0xf bank_mask:0xf
    v_add_f32_dpp v59, v57, v57 quad_perm:[1,0,3,2] row_mask:0xf bank_mask:0xf
    v_mov_b32 v32, v33
    v_mov_b32 v33, v34
    v_mov_b32 v34, v35
    v_mov_b32 v35, v36
    v_mov_b32 v36, v37
    v_mov_b32 v37, v38
    v_mov_b32 v38, v39
    v_cndmask_b32_e64 v39, v58, v59, s[66:67]
    s_waitcnt vmcnt(5)
    s_add_u32 s75, s75, s74
    s_cbranch_scc1 L_f75
    s_waitcnt vmcnt(4)
L_f75:
    buffer_load_dwordx4 v[180:183], v22, s[24:27], s60 offen offset:1024 nt
    v_dot2_f32_bf16 v49, v148, v28, 0
    v_dot2_f32_bf16 v49, v149, v29, v49
    v_dot2_f32_bf16 v49, v150, v30, v49
    v_dot2_f32_bf16 v49, v151, v31, v49
    v_add_f32_dpp v53, v50, v50 row_ror:8 row_mask:0xf bank_mask:0x3
    v_add_f32_dpp v53, v51, v51 row_ror:8 row_mask:0xf bank_mask:0xc
    s_waitcnt vmcnt(5)
    s_add_u32 s75, s75, s74
    s_cbranch_scc1 L_f76
    s_waitcnt vmcnt(4)
L_f76:
    buffer_load_dwordx4 v[184:187], v22, s[24:27], s60 offen offset:2048 nt
    v_dot2_f32_bf16 v50, v152, v28, 0
    v_dot2_f32_bf16 v50, v153, v29, v50
    v_dot2_f32_bf16 v50, v154, v30, v50
    v_dot2_f32_bf16 v50, v155, v31, v50
    v_add_f32_dpp v54, v52, v52 row_half_mirror row_mask:0xf bank_mask:0x5
    v_add_f32_dpp v54, v53, v53 row_half_mirror row_mask:0xf bank_mask:0xa
    s_waitcnt vmcnt(5)
    s_add_u32 s75, s75, s74
    s_cbranch_scc1 L_f77
    s_waitcnt vmcnt(4)
L_f77:
    buffer_load_dwordx4 v[188:191], v22, s[24:27], s60 offen offset:3072 nt
    s_or_b32 s60, s60, 0x13000
    s_add_u32 s60, s60, 0x4000
    s_and_b32 s60, s60, 0xecfff
    s_add_u32 s63, s63, 1
    s_cmp_lg_u32 s63, s40
    s_cselect_b64 s[24:25], s[24:25], s[28:29]
    s_cselect_b64 s[28:29], s[28:29], s[30:31]
    s_cselect_b64 s[30:31], s[30:31], s[36:37]
    s_cselect_b64 s[36:37], s[36:37], s[42:43]
    s_cselect_b32 s3, 0, s41
    s_cselect_b32 s41, s41, 32
    s_add_u32 s40, s40, s3
    v_dot2_f32_bf16 v51, v156, v28, 0
    v_dot2_f32_bf16 v51, v157, v29, v51
    v_dot2_f32_bf16 v51, v158, v30, v51
    v_dot2_f32_bf16 v51, v159, v31, v51
    v_add_f32_dpp v52, v48, v48 row_ror:8 row_mask:0xf bank_mask:0x3
    v_add_f32_dpp v52, v49, v49 row_ror:8 row_mask:0xf bank_mask:0xc
    s_waitcnt lgkmcnt(0)
    s_add_u32 s39, s39, 4
    v_readfirstlane_b32 s74, v70
    v_mov_b32 v71, s39
    ds_write_b32 v25, v71 offset:4256
    ds_read_b32 v70, v25 offset:4272
    s_waitcnt vmcnt(5)
    s_add_u32 s75, s75, s74
    s_cbranch_scc1 L_f78
    s_waitcnt vmcnt(4)
L_f78:
    buffer_load_dwordx4 v[128:131], v22, s[24:27], s60 offen nt
    v_dot2_f32_bf16 v48, v160, v28, 0
    v_dot2_f32_bf16 v48, v161, v29, v48
    v_dot2_f32_bf16 v48, v162, v30, v48
    v_dot2_f32_bf16 v48, v163, v31, v48
    v_add_f32_dpp v53, v50, v50 row_ror:8 row_mask:0xf bank_mask:0x3
    v_add_f32_dpp v53, v51, v51 row_ror:8 row_mask:0xf bank_mask:0xc
    s_waitcnt vmcnt(5)
    s_add_u32 s75, s75, s74
    s_cbranch_scc1 L_f79
    s_waitcnt vmcnt(4)
L_f79:
    buffer_load_dwordx4 v[132:135], v22, s[24:27], s60 offen offset:1024 nt
    v_dot2_f32_bf16 v49, v164, v28, 0
    v_dot2_f32_bf16 v49, v165, v29, v49
    v_dot2_f32_bf16 v49, v166, v30, v49
    v_dot2_f32_bf16 v49, v167, v31, v49
    v_add_f32_dpp v55, v52, v52 row_half_mirror row_mask:0xf bank_mask:0x5
    v_add_f32_dpp v55, v53, v53 row_half_mirror row_mask:0xf bank_mask:0xa
    s_waitcnt vmcnt(5)
    s_add_u32 s75, s75, s74
    s_cbranch_scc1 L_f80
    s_waitcnt vmcnt(4)
L_f80:
    buffer_load_dwordx4 v[136:139], v22, s[24:27], s60 offen offset:2048 nt
    v_dot2_f32_bf16 v50, v168, v28, 0
    v_dot2_f32_bf16 v50, v169, v29, v50
    v_dot2_f32_bf16 v50, v170, v30, v50
    v_dot2_f32_bf16 v50, v171, v31, v50
    v_add_f32_dpp v58, v54, v54 quad_perm:[2,3,0,1] row_mask:0xf bank_mask:0xf
    v_add_f32_dpp v59, v55, v55 quad_perm:[2,3,0,1] row_mask:0xf bank_mask:0xf
    v_cndmask_b32_e64 v56, v58, v59, s[64:65]
    s_waitcnt vmcnt(5)
    s_add_u32 s75, s75, s74
    s_cbranch_scc1 L_f81
    s_waitcnt vmcnt(4)
L_f81:
    buffer_load_dwordx4 v[140:143], v22, s[24:27], s60 offen offset:3072 nt
    s_or_b32 s60, s60, 0x13000
    s_add_u32 s60, s60, 0x4000
    s_and_b32 s60, s60, 0xecfff
    s_add_u32 s63, s63, 1
    s_cmp_lg_u32 s63, s40
    s_cselect_b64 s[24:25], s[24:25], s[28:29]
    s_cselect_b64 s[28:29], s[28:29], s[30:31]
    s_cselect_b64 s[30:31], s[30:31], s[36:37]
    s_cselect_b64 s[36:37], s[36:37], s[42:43]
    s_cselect_b32 s3, 0, s41
    s_cselect_b32 s41, s41, 32
    s_add_u32 s40, s40, s3
    v_dot2_f32_bf16 v51, v172, v28, 0
    v_dot2_f32_bf16 v51, v173, v29, v51
    v_dot2_f32_bf16 v51, v174, v30, v51
    v_dot2_f32_bf16 v51, v175, v31, v51
    v_add_f32_dpp v52, v48, v48 row_ror:8 row_mask:0xf bank_mask:0x3
    v_add_f32_dpp v52, v49, v49 row_ror:8 row_mask:0xf bank_mask:0xc
    s_waitcnt lgkmcnt(0)
    s_add_u32 s39, s39, 4
    v_readfirstlane_b32 s74, v70
    v_mov_b32 v71, s39
    ds_write_b32 v25, v71 offset:4256
    ds_read_b32 v70, v25 offset:4272
    s_waitcnt vmcnt(5)
    s_add_u32 s75, s75, s74
    s_cbranch_scc1 L_f82
    s_waitcnt vmcnt(4)
L_f82:
    buffer_load_dwordx4 v[144:147], v22, s[24:27], s60 offen nt
    v_dot2_f32_bf16 v48, v176, v28, 0
    v_dot2_f32_bf16 v48, v177, v29, v48
    v_dot2_f32_bf16 v48, v178, v30, v48
    v_dot2_f32_bf16 v48, v179, v31, v48
    v_add_f32_dpp v53, v50, v50 row_ror:8 row_mask:0xf bank_mask:0x3
    v_add_f32_dpp v53, v51, v51 row_ror:8 row_mask:0xf bank_mask:0xc
    s_waitcnt vmcnt(5)
    s_add_u32 s75, s75, s74
    s_cbranch_scc1 L_f83
    s_waitcnt vmcnt(4)
L_f83:
    buffer_load_dwordx4 v[148:151], v22, s[24:27], s60 offen offset:1024 nt
    v_dot2_f32_bf16 v49, v180, v28, 0
    v_dot2_f32_bf16 v49, v181, v29, v49
    v_dot2_f32_bf16 v49, v182, v30, v49
    v_dot2_f32_bf16 v49, v183, v31, v49
    v_add_f32_dpp v54, v52, v52 row_half_mirror row_mask:0xf bank_mask:0x5
    v_add_f32_dpp v54, v53, v53 row_half_mirror row_mask:0xf bank_mask:0xa
    s_waitcnt vmcnt(5)
    s_add_u32 s75, s75, s74
    s_cbranch_scc1 L_f84
    s_waitcnt vmcnt(4)
L_f84:
    buffer_load_dwordx4 v[152:155], v22, s[24:27], s60 offen offset:2048 nt
    v_dot2_f32_bf16 v50, v184, v28, 0
    v_dot2_f32_bf16 v50, v185, v29, v50
    v_dot2_f32_bf16 v50, v186, v30, v50
    v_dot2_f32_bf16 v50, v187, v31, v50
    v_add_f32_dpp v52, v48, v48 row_ror:8 row_mask:0xf bank_mask:0x3
    v_add_f32_dpp v52, v49, v49 row_ror:8 row_mask:0xf bank_mask:0xc
    s_waitcnt vmcnt(5)
    s_add_u32 s75, s75, s74
    s_cbranch_scc1 L_f85
    s_waitcnt vmcnt(4)
L_f85:
    buffer_load_dwordx4 v[156:159], v22, s[24:27], s60 offen offset:3072 nt
    s_or_b32 s60, s60, 0x13000
    s_add_u32 s60, s60, 0x4000
    s_and_b32 s60, s60, 0xecfff
    s_add_u32 s63, s63, 1
    s_cmp_lg_u32 s63, s40
    s_cselect_b64 s[24:25], s[24:25], s[28:29]
    s_cselect_b64 s[28:29], s[28:29], s[30:31]
    s_cselect_b64 s[30:31], s[30:31], s[36:37]
    s_cselect_b64 s[36:37], s[36:37], s[42:43]
    s_cselect_b32 s3, 0, s41
    s_cselect_b32 s41, s41, 32
    s_add_u32 s40, s40, s3
    v_dot2_f32_bf16 v51, v188, v28, 0
    v_dot2_f32_bf16 v51, v189, v29, v51
    v_dot2_f32_bf16 v51, v190, v30, v51
    v_dot2_f32_bf16 v51, v191, v31, v51
    s_sub_u32 s73, s73, 1
    s_cmp_lg_u32 s73, 0
    s_nop 0
    s_cbranch_scc1 L_kB0
    s_waitcnt vmcnt(4)
    buffer_load_dwordx4 v[160:163], v22, s[24:27], s60 offen nt
    v_add_f32_dpp v53, v50, v50 row_ror:8 row_mask:0xf bank_mask:0x3
    v_add_f32_dpp v53, v51, v51 row_ror:8 row_mask:0xf bank_mask:0xc
    v_add_f32_dpp v55, v52, v52 row_half_mirror row_mask:0xf bank_mask:0x5
    s_nop 0
    v_add_f32_dpp v55, v53, v53 row_half_mirror row_mask:0xf bank_mask:0xa
    v_add_f32_dpp v58, v54, v54 quad_perm:[2,3,0,1] row_mask:0xf bank_mask:0xf
    s_nop 0
    v_add_f32_dpp v59, v55, v55 quad_perm:[2,3,0,1] row_mask:0xf bank_mask:0xf
    v_cndmask_b32_e64 v57, v58, v59, s[64:65]
    v_add_f32_dpp v58, v56, v56 quad_perm:[1,0,3,2] row_mask:0xf bank_mask:0xf
    s_nop 0
    v_add_f32_dpp v59, v57, v57 quad_perm:[1,0,3,2] row_mask:0xf bank_mask:0xf
    v_mov_b32 v32, v33
    v_mov_b32 v33, v34
    v_mov_b32 v34, v35
    v_mov_b32 v35, v36
    v_mov_b32 v36, v37
    v_mov_b32 v37, v38
    v_mov_b32 v38, v39
    v_cndmask_b32_e64 v39, v58, v59, s[66:67]
    v_max3_f32 v17, v32, v33, v34
    v_max3_f32 v17, v17, v35, v36
    v_max3_f32 v17, v17, v37, v38
    v_max_f32 v17, v17, v39
    s_nop 1
    v_max_f32_dpp v17, v17, v17 row_ror:8 row_mask:0xf bank_mask:0xf
    s_nop 1
    v_max_f32_dpp v17, v17, v17 row_ror:4 row_mask:0xf bank_mask:0xf
    s_nop 1
    v_max_f32_dpp v17, v17, v17 row_ror:2 row_mask:0xf bank_mask:0xf
    s_nop 1
    v_max_f32_dpp v17, v17, v17 row_ror:1 row_mask:0xf bank_mask:0xf
    s_nop 1
    v_max_f32_dpp v17, v17, v17 row_bcast:15 row_mask:0xa bank_mask:0xf
    s_nop 1
    v_max_f32_dpp v17, v17, v17 row_bcast:31 row_mask:0xc bank_mask:0xf
    s_nop 0
    v_readlane_b32 s68, v17, 63
    s_waitcnt vmcnt(4)
    buffer_load_dwordx4 v[164:167], v22, s[24:27], s60 offen offset:1024 nt
    v_mov_b32 v20, s68
    v_mul_f32 v20, s72, v20
    v_fma_f32 v32, v32, s72, -v20
    v_fma_f32 v33, v33, s72, -v20
    v_fma_f32 v34, v34, s72, -v20
    v_fma_f32 v35, v35, s72, -v20
    v_fma_f32 v36, v36, s72, -v20
    v_fma_f32 v37, v37, s72, -v20
    v_fma_f32 v38, v38, s72, -v20
    v_fma_f32 v39, v39, s72, -v20
    v_exp_f32 v32, v32
    v_exp_f32 v33, v33
    v_exp_f32 v34, v34
    v_exp_f32 v35, v35
    v_exp_f32 v36, v36
    v_exp_f32 v37, v37
    v_exp_f32 v38, v38
    v_exp_f32 v39, v39
    s_waitcnt vmcnt(4)
    buffer_load_dwordx4 v[168:171], v22, s[24:27], s60 offen offset:2048 nt
    v_add_f32 v17, v32, v33
    v_add_f32 v17, v17, v34
    v_add_f32 v17, v17, v35
    v_add_f32 v17, v17, v36
    v_add_f32 v17, v17, v37
    v_add_f32 v17, v17, v38
    v_add_f32 v17, v17, v39
    v_cvt_pk_bf16_f32 v32, v32, v32
    v_cvt_pk_bf16_f32 v33, v33, v33
    v_cvt_pk_bf16_f32 v34, v34, v34
    v_cvt_pk_bf16_f32 v35, v35, v35
    v_cvt_pk_bf16_f32 v36, v36, v36
    v_cvt_pk_bf16_f32 v37, v37, v37
    v_cvt_pk_bf16_f32 v38, v38, v38
    v_cvt_pk_bf16_f32 v39, v39, v39
    v_add_f32_dpp v17, v17, v17 row_ror:8 row_mask:0xf bank_mask:0xf
    s_nop 1
    v_add_f32_dpp v17, v17, v17 row_ror:4 row_mask:0xf bank_mask:0xf
    s_nop 1
    v_add_f32_dpp v17, v17, v17 row_ror:2 row_mask:0xf bank_mask:0xf
    s_nop 1
    v_add_f32_dpp v17, v17, v17 row_ror:1 row_mask:0xf bank_mask:0xf
    s_nop 1
    v_add_f32_dpp v17, v17, v17 row_bcast:15 row_mask:0xa bank_mask:0xf
    s_nop 1
    v_add_f32_dpp v17, v17, v17 row_bcast:31 row_mask:0xc bank_mask:0xf
    s_nop 0
    v_readlane_b32 s69, v17, 63
    s_waitcnt vmcnt(4)
    buffer_load_dwordx4 v[172:175], v22, s[24:27], s60 offen offset:3072 nt
    s_or_b32 s60, s60, 0x13000
    s_add_u32 s60, s60, 0x4000
    s_and_b32 s60, s60, 0xecfff
    s_add_u32 s63, s63, 1
    s_cmp_lg_u32 s63, s40
    s_cselect_b64 s[24:25], s[24:25], s[28:29]
    s_cselect_b64 s[28:29], s[28:29], s[30:31]
    s_cselect_b64 s[30:31], s[30:31], s[36:37]
    s_cselect_b64 s[36:37], s[36:37], s[42:43]
    s_cselect_b32 s3, 0, s41
    s_cselect_b32 s41, s41, 32
    s_add_u32 s40, s40, s3
    v_mov_b32 v21, s69
    s_lshl_b32 s3, s56, 3
    v_mov_b32 v17, s3
    s_mov_b64 exec, 1
    ds_write_b64 v17, v[20:21] offset:4160
    s_mov_b64 exec, -1
    v_mov_b32 v60, 0
    v_mov_b32 v61, 0
    v_mov_b32 v62, 0
    v_mov_b32 v63, 0
    v_and_b32_dpp v8, v32, v4 row_newbcast:0 row_mask:0xf bank_mask:0xf
    v_and_b32_dpp v9, v32, v5 row_newbcast:0 row_mask:0xf bank_mask:0xf
    v_and_b32_dpp v10, v32, v6 row_newbcast:0 row_mask:0xf bank_mask:0xf
    v_and_b32_dpp v11, v32, v7 row_newbcast:0 row_mask:0xf bank_mask:0xf
    s_mov_b32 s73, 7
    s_nop 0
L_vB0:
    s_waitcnt lgkmcnt(0)
    s_add_u32 s39, s39, 4
    v_readfirstlane_b32 s74, v70
    v_mov_b32 v71, s39
    ds_write_b32 v25, v71 offset:4256
    ds_read_b32 v70, v25 offset:4272
    s_waitcnt vmcnt(5)
    s_add_u32 s75, s75, s74
    s_cbranch_scc1 L_f86
    s_waitcnt vmcnt(4)
L_f86:
    buffer_load_dwordx4 v[176:179], v22, s[24:27], s60 offen nt
    v_mfma_f32_16x16x32_bf16 v[60:63], v[8:11], v[128:131], v[60:63]
    v_and_b32_dpp v12, v32, v4 row_newbcast:8 row_mask:0xf bank_mask:0xf
    v_and_b32_dpp v13, v32, v5 row_newbcast:8 row_mask:0xf bank_mask:0xf
    v_and_b32_dpp v14, v32, v6 row_newbcast:8 row_mask:0xf bank_mask:0xf
    v_and_b32_dpp v15, v32, v7 row_newbcast:8 row_mask:0xf bank_mask:0xf
    s_waitcnt vmcnt(5)
    s_add_u32 s75, s75, s74
    s_cbranch_scc1 L_f87
    s_waitcnt vmcnt(4)
L_f87:
    buffer_load_dwordx4 v[180:183], v22, s[24:27], s60 offen offset:1024 nt
    v_mfma_f32_16x16x32_bf16 v[60:63], v[12:15], v[132:135], v[60:63]
    v_and_b32_dpp v8, v32, v4 row_newbcast:4 row_mask:0xf bank_mask:0xf
    v_and_b32_dpp v9, v32, v5 row_newbcast:4 row_mask:0xf bank_mask:0xf
    v_and_b32_dpp v10, v32, v6 row_newbcast:4 row_mask:0xf bank_mask:0xf
    v_and_b32_dpp v11, v32, v7 row_newbcast:4 row_mask:0xf bank_mask:0xf
    s_waitcnt vmcnt(5)
    s_add_u32 s75, s75, s74
    s_cbranch_scc1 L_f88
    s_waitcnt vmcnt(4)
L_f88:
    buffer_load_dwordx4 v[184:187], v22, s[24:27], s60 offen offset:2048 nt
    v_mfma_f32_16x16x32_bf16 v[60:63], v[8:11], v[136:139], v[60:63]
    v_and_b32_dpp v12, v32, v4 row_newbcast:12 row_mask:0xf bank_mask:0xf
    v_and_b32_dpp v13, v32, v5 row_newbcast:12 row_mask:0xf bank_mask:0xf
    v_and_b32_dpp v14, v32, v6 row_newbcast:12 row_mask:0xf bank_mask:0xf
    v_and_b32_dpp v15, v32, v7 row_newbcast:12 row_mask:0xf bank_mask:0xf
    s_waitcnt vmcnt(5)
    s_add_u32 s75, s75, s74
    s_cbranch_scc1 L_f89
    s_waitcnt vmcnt(4)
L_f89:
    buffer_load_dwordx4 v[188:191], v22, s[24:27], s60 offen offset:3072 nt
    s_or_b32 s60, s60, 0x13000
    s_add_u32 s60, s60, 0x4000
    s_and_b32 s60, s60, 0xecfff
    s_add_u32 s63, s63, 1
    s_cmp_lg_u32 s63, s40
    s_cselect_b64 s[24:25], s[24:25], s[28:29]
    s_cselect_b64 s[28:29], s[28:29], s[30:31]
    s_cselect_b64 s[30:31], s[30:31], s[36:37]
    s_cselect_b64 s[36:37], s[36:37], s[42:43]
    s_cselect_b32 s3, 0, s41
    s_cselect_b32 s41, s41, 32
    s_add_u32 s40, s40, s3
    v_mfma_f32_16x16x32_bf16 v[60:63], v[12:15], v[140:143], v[60:63]
    v_and_b32_dpp v8, v32, v4 row_newbcast:2 row_mask:0xf bank_mask:0xf
    v_and_b32_dpp v9, v32, v5 row_newbcast:2 row_mask:0xf bank_mask:0xf
    v_and_b32_dpp v10, v32, v6 row_newbcast:2 row_mask:0xf bank_mask:0xf
    v_and_b32_dpp v11, v32, v7 row_newbcast:2 row_mask:0xf bank_mask:0xf
    s_waitcnt lgkmcnt(0)
    s_add_u32 s39, s39, 4
    v_readfirstlane_b32 s74, v70
    v_mov_b32 v71, s39
    ds_write_b32 v25, v71 offset:4256
    ds_read_b32 v70, v25 offset:4272
    s_waitcnt vmcnt(5)
    s_add_u32 s75, s75, s74
    s_cbranch_scc1 L_f90
    s_waitcnt vmcnt(4)
L_f90:
    buffer_load_dwordx4 v[128:131], v22, s[24:27], s60 offen nt
    v_mfma_f32_16x16x32_bf16 v[60:63], v[8:11], v[144:147], v[60:63]
    v_and_b32_dpp v12, v32, v4 row_newbcast:10 row_mask:0xf bank_mask:0xf
    v_and_b32_dpp v13, v32, v5 row_newbcast:10 row_mask:0xf bank_mask:0xf
    v_and_b32_dpp v14, v32, v6 row_newbcast:10 row_mask:0xf bank_mask:0xf
    v_and_b32_dpp v15, v32, v7 row_newbcast:10 row_mask:0xf bank_mask:0xf
    s_waitcnt vmcnt(5)
    s_add_u32 s75, s75, s74
    s_cbranch_scc1 L_f91
    s_waitcnt vmcnt(4)
L_f91:
    buffer_load_dwordx4 v[132:135], v22, s[24:27], s60 offen offset:1024 nt
    v_mfma_f32_16x16x32_bf16 v[60:63], v[12:15], v[148:151], v[60:63]
    v_and_b32_dpp v8, v32, v4 row_newbcast:6 row_mask:0xf bank_mask:0xf
    v_and_b32_dpp v9, v32, v5 row_newbcast:6 row_mask:0xf bank_mask:0xf
    v_and_b32_dpp v10, v32, v6 row_newbcast:6 row_mask:0xf bank_mask:0xf
    v_and_b32_dpp v11, v32, v7 row_newbcast:6 row_mask:0xf bank_mask:0xf
    s_waitcnt vmcnt(5)
    s_add_u32 s75, s75, s74
    s_cbranch_scc1 L_f92
    s_waitcnt vmcnt(4)
L_f92:
    buffer_load_dwordx4 v[136:139], v22, s[24:27], s60 offen offset:2048 nt
    v_mfma_f32_16x16x32_bf16 v[60:63], v[8:11], v[152:155], v[60:63]
    v_and_b32_dpp v12, v32, v4 row_newbcast:14 row_mask:0xf bank_mask:0xf
    v_and_b32_dpp v13, v32, v5 row_newbcast:14 row_mask:0xf bank_mask:0xf
    v_and_b32_dpp v14, v32, v6 row_newbcast:14 row_mask:0xf bank_mask:0xf
    v_and_b32_dpp v15, v32, v7 row_newbcast:14 row_mask:0xf bank_mask:0xf
    s_waitcnt vmcnt(5)
    s_add_u32 s75, s75, s74
    s_cbranch_scc1 L_f93
    s_waitcnt vmcnt(4)
L_f93:
    buffer_load_dwordx4 v[140:143], v22, s[24:27], s60 offen offset:3072 nt
    s_or_b32 s60, s60, 0x13000
    s_add_u32 s60, s60, 0x4000
    s_and_b32 s60, s60, 0xecfff
    s_add_u32 s63, s63, 1
    s_cmp_lg_u32 s63, s40
    s_cselect_b64 s[24:25], s[24:25], s[28:29]
    s_cselect_b64 s[28:29], s[28:29], s[30:31]
    s_cselect_b64 s[30:31], s[30:31], s[36:37]
    s_cselect_b64 s[36:37], s[36:37], s[42:43]
    s_cselect_b32 s3, 0, s41
    s_cselect_b32 s41, s41, 32
    s_add_u32 s40, s40, s3
    v_mfma_f32_16x16x32_bf16 v[60:63], v[12:15], v[156:159], v[60:63]
    v_and_b32_dpp v8, v32, v4 row_newbcast:1 row_mask:0xf bank_mask:0xf
    v_and_b32_dpp v9, v32, v5 row_newbcast:1 row_mask:0xf bank_mask:0xf
    v_and_b32_dpp v10, v32, v6 row_newbcast:1 row_mask:0xf bank_mask:0xf
    v_and_b32_dpp v11, v32, v7 row_newbcast:1 row_mask:0xf bank_mask:0xf
    s_waitcnt lgkmcnt(0)
    s_add_u32 s39, s39, 4
    v_readfirstlane_b32 s74, v70
    v_mov_b32 v71, s39
    ds_write_b32 v25, v71 offset:4256
    ds_read_b32 v70, v25 offset:4272
    s_waitcnt vmcnt(5)
    s_add_u32 s75, s75, s74
    s_cbranch_scc1 L_f94
    s_waitcnt vmcnt(4)
L_f94:
    buffer_load_dwordx4 v[144:147], v22, s[24:27], s60 offen nt
    v_mfma_f32_16x16x32_bf16 v[60:63], v[8:11], v[160:163], v[60:63]
    v_and_b32_dpp v12, v32, v4 row_newbcast:9 row_mask:0xf bank_mask:0xf
    v_and_b32_dpp v13, v32, v5 row_newbcast:9 row_mask:0xf bank_mask:0xf
    v_and_b32_dpp v14, v32, v6 row_newbcast:9 row_mask:0xf bank_mask:0xf
    v_and_b32_dpp v15, v32, v7 row_newbcast:9 row_mask:0xf bank_mask:0xf
    s_waitcnt vmcnt(5)
    s_add_u32 s75, s75, s74
    s_cbranch_scc1 L_f95
    s_waitcnt vmcnt(4)
L_f95:
    buffer_load_dwordx4 v[148:151], v22, s[24:27], s60 offen offset:1024 nt
    v_mfma_f32_16x16x32_bf16 v[60:63], v[12:15], v[164:167], v[60:63]
    v_and_b32_dpp v8, v32, v4 row_newbcast:5 row_mask:0xf bank_mask:0xf
    v_and_b32_dpp v9, v32, v5 row_newbcast:5 row_mask:0xf bank_mask:0xf
    v_and_b32_dpp v10, v32, v6 row_newbcast:5 row_mask:0xf bank_mask:0xf
    v_and_b32_dpp v11, v32, v7 row_newbcast:5 row_mask:0xf bank_mask:0xf
    s_waitcnt vmcnt(5)
    s_add_u32 s75, s75, s74
    s_cbranch_scc1 L_f96
    s_waitcnt vmcnt(4)
L_f96:
    buffer_load_dwordx4 v[152:155], v22, s[24:27], s60 offen offset:2048 nt
    v_mfma_f32_16x16x32_bf16 v[60:63], v[8:11], v[168:171], v[60:63]
    v_and_b32_dpp v12, v32, v4 row_newbcast:13 row_mask:0xf bank_mask:0xf
    v_and_b32_dpp v13, v32, v5 row_newbcast:13 row_mask:0xf bank_mask:0xf
    v_and_b32_dpp v14, v32, v6 row_newbcast:13 row_mask:0xf bank_mask:0xf
    v_and_b32_dpp v15, v32, v7 row_newbcast:13 row_mask:0xf bank_mask:0xf
    s_waitcnt vmcnt(5)
    s_add_u32 s75, s75, s74
    s_cbranch_scc1 L_f97
    s_waitcnt vmcnt(4)
L_f97:
    buffer_load_dwordx4 v[156:159], v22, s[24:27], s60 offen offset:3072 nt
    s_or_b32 s60, s60, 0x13000
    s_add_u32 s60, s60, 0x4000
    s_and_b32 s60, s60, 0xecfff
    s_add_u32 s63, s63, 1
    s_cmp_lg_u32 s63, s40
    s_cselect_b64 s[24:25], s[24:25], s[28:29]
    s_cselect_b64 s[28:29], s[28:29], s[30:31]
    s_cselect_b64 s[30:31], s[30:31], s[36:37]
    s_cselect_b64 s[36:37], s[36:37], s[42:43]
    s_cselect_b32 s3, 0, s41
    s_cselect_b32 s41, s41, 32
    s_add_u32 s40, s40, s3
    v_mfma_f32_16x16x32_bf16 v[60:63], v[12:15], v[172:175], v[60:63]
    v_and_b32_dpp v8, v32, v4 row_newbcast:3 row_mask:0xf bank_mask:0xf
    v_and_b32_dpp v9, v32, v5 row_newbcast:3 row_mask:0xf bank_mask:0xf
    v_and_b32_dpp v10, v32, v6 row_newbcast:3 row_mask:0xf bank_mask:0xf
    v_and_b32_dpp v11, v32, v7 row_newbcast:3 row_mask:0xf bank_mask:0xf
    s_waitcnt lgkmcnt(0)
    s_add_u32 s39, s39, 4
    v_readfirstlane_b32 s74, v70
    v_mov_b32 v71, s39
    ds_write_b32 v25, v71 offset:4256
    ds_read_b32 v70, v25 offset:4272
    s_waitcnt vmcnt(5)
    s_add_u32 s75, s75, s74
    s_cbranch_scc1 L_f98
    s_waitcnt vmcnt(4)
L_f98:
    buffer_load_dwordx4 v[160:163], v22, s[24:27], s60 offen nt
    v_mfma_f32_16x16x32_bf16 v[60:63], v[8:11], v[176:179], v[60:63]
    v_and_b32_dpp v12, v32, v4 row_newbcast:11 row_mask:0xf bank_mask:0xf
    v_and_b32_dpp v13, v32, v5 row_newbcast:11 row_mask:0xf bank_mask:0xf
    v_and_b32_dpp v14, v32, v6 row_newbcast:11 row_mask:0xf bank_mask:0xf
    v_and_b32_dpp v15, v32, v7 row_newbcast:11 row_mask:0xf bank_mask:0xf
    s_waitcnt vmcnt(5)
    s_add_u32 s75, s75, s74
    s_cbranch_scc1 L_f99
    s_waitcnt vmcnt(4)
L_f99:
    buffer_load_dwordx4 v[164:167], v22, s[24:27], s60 offen offset:1024 nt
    v_mfma_f32_16x16x32_bf16 v[60:63], v[12:15], v[180:183], v[60:63]
    v_and_b32_dpp v8, v32, v4 row_newbcast:7 row_mask:0xf bank_mask:0xf
    v_and_b32_dpp v9, v32, v5 row_newbcast:7 row_mask:0xf bank_mask:0xf
    v_and_b32_dpp v10, v32, v6 row_newbcast:7 row_mask:0xf bank_mask:0xf
    v_and_b32_dpp v11, v32, v7 row_newbcast:7 row_mask:0xf bank_mask:0xf
    s_waitcnt vmcnt(5)
    s_add_u32 s75, s75, s74
    s_cbranch_scc1 L_f100
    s_waitcnt vmcnt(4)
L_f100:
    buffer_load_dwordx4 v[168:171], v22, s[24:27], s60 offen offset:2048 nt
    v_mfma_f32_16x16x32_bf16 v[60:63], v[8:11], v[184:187], v[60:63]
    v_and_b32_dpp v12, v32, v4 row_newbcast:15 row_mask:0xf bank_mask:0xf
    v_and_b32_dpp v13, v32, v5 row_newbcast:15 row_mask:0xf bank_mask:0xf
    v_and_b32_dpp v14, v32, v6 row_newbcast:15 row_mask:0xf bank_mask:0xf
    v_and_b32_dpp v15, v32, v7 row_newbcast:15 row_mask:0xf bank_mask:0xf
    s_waitcnt vmcnt(5)
    s_add_u32 s75, s75, s74
    s_cbranch_scc1 L_f101
    s_waitcnt vmcnt(4)
L_f101:
    buffer_load_dwordx4 v[172:175], v22, s[24:27], s60 offen offset:3072 nt
    s_or_b32 s60, s60, 0x13000
    s_add_u32 s60, s60, 0x4000
    s_and_b32 s60, s60, 0xecfff
    s_add_u32 s63, s63, 1
    s_cmp_lg_u32 s63, s40
    s_cselect_b64 s[24:25], s[24:25], s[28:29]
    s_cselect_b64 s[28:29], s[28:29], s[30:31]
    s_cselect_b64 s[30:31], s[30:31], s[36:37]
    s_cselect_b64 s[36:37], s[36:37], s[42:43]
    s_cselect_b32 s3, 0, s41
    s_cselect_b32 s41, s41, 32
    s_add_u32 s40, s40, s3
    v_mfma_f32_16x16x32_bf16 v[60:63], v[12:15], v[188:191], v[60:63]
    v_and_b32_dpp v8, v33, v4 row_newbcast:0 row_mask:0xf bank_mask:0xf
    v_and_b32_dpp v9, v33, v5 row_newbcast:0 row_mask:0xf bank_mask:0xf
    v_and_b32_dpp v10, v33, v6 row_newbcast:0 row_mask:0xf bank_mask:0xf
    v_and_b32_dpp v11, v33, v7 row_newbcast:0 row_mask:0xf bank_mask:0xf
    v_mov_b32 v32, v33
    v_mov_b32 v33, v34
    v_mov_b32 v34, v35
    v_mov_b32 v35, v36
    v_mov_b32 v36, v37
    v_mov_b32 v37, v38
    v_mov_b32 v38, v39
    s_sub_u32 s73, s73, 1
    s_cmp_lg_u32 s73, 0
    s_cbranch_scc1 L_vB0
    buffer_load_dwordx4 v[176:179], v22, s[24:27], s60 offen nt
    s_mov_b32 s70, 0
L_m102:
    ds_read_b128 v[40:43], v24 offset:4160
    ds_read_b128 v[44:47], v24 offset:4176
    s_add_u32 s70, s70, 1
    s_waitcnt lgkmcnt(0)
    v_min3_u32 v18, v41, v43, v45
    v_min3_u32 v18, v18, v47, v47
    s_cmp_ge_u32 s70, 0x100000
    v_readfirstlane_b32 s3, v18
    s_cbranch_scc1 L_m102_ok
    s_cmp_lg_u32 s3, 0
    s_cbranch_scc0 L_m102
L_m102_ok:
    buffer_load_dwordx4 v[180:183], v22, s[24:27], s60 offen offset:1024 nt
    v_max3_f32 v17, v40, v42, v44
    v_max_f32 v17, v17, v46
    v_sub_f32 v20, v20, v17
    v_exp_f32 v20, v20
    s_waitcnt lgkmcnt(0)
    s_add_u32 s39, s39, 16
    v_readfirstlane_b32 s74, v70
    v_mov_b32 v71, s39
    ds_write_b32 v25, v71 offset:4256
    ds_read_b32 v70, v25 offset:4272
    s_waitcnt vmcnt(7)
    buffer_load_dwordx4 v[184:187], v22, s[24:27], s60 offen offset:2048 nt
    v_mfma_f32_16x16x32_bf16 v[60:63], v[8:11], v[128:131], v[60:63]
    v_and_b32_dpp v12, v32, v4 row_newbcast:8 row_mask:0xf bank_mask:0xf
    v_and_b32_dpp v13, v32, v5 row_newbcast:8 row_mask:0xf bank_mask:0xf
    v_and_b32_dpp v14, v32, v6 row_newbcast:8 row_mask:0xf bank_mask:0xf
    v_and_b32_dpp v15, v32, v7 row_newbcast:8 row_mask:0xf bank_mask:0xf
    s_waitcnt vmcnt(7)
    buffer_load_dwordx4 v[188:191], v22, s[24:27], s60 offen offset:3072 nt
    s_or_b32 s60, s60, 0x13000
    s_add_u32 s60, s60, 0x4000
    s_and_b32 s60, s60, 0xecfff
    s_add_u32 s63, s63, 1
    s_cmp_lg_u32 s63, s40
    s_cselect_b64 s[24:25], s[24:25], s[28:29]
    s_cselect_b64 s[28:29], s[28:29], s[30:31]
    s_cselect_b64 s[30:31], s[30:31], s[36:37]
    s_cselect_b64 s[36:37], s[36:37], s[42:43]
    s_cselect_b32 s3, 0, s41
    s_cselect_b32 s41, s41, 32
    s_add_u32 s40, s40, s3
    v_mfma_f32_16x16x32_bf16 v[60:63], v[12:15], v[132:135], v[60:63]
    v_and_b32_dpp v8, v32, v4 row_newbcast:4 row_mask:0xf bank_mask:0xf
    v_and_b32_dpp v9, v32, v5 row_newbcast:4 row_mask:0xf bank_mask:0xf
    v_and_b32_dpp v10, v32, v6 row_newbcast:4 row_mask:0xf bank_mask:0xf
    v_and_b32_dpp v11, v32, v7 row_newbcast:4 row_mask:0xf bank_mask:0xf
    s_waitcnt vmcnt(7)
    buffer_load_dwordx4 v[128:131], v22, s[24:27], s60 offen nt
    v_mfma_f32_16x16x32_bf16 v[60:63], v[8:11], v[136:139], v[60:63]
    v_and_b32_dpp v12, v32, v4 row_newbcast:12 row_mask:0xf bank_mask:0xf
    v_and_b32_dpp v13, v32, v5 row_newbcast:12 row_mask:0xf bank_mask:0xf
    v_and_b32_dpp v14, v32, v6 row_newbcast:12 row_mask:0xf bank_mask:0xf
    v_and_b32_dpp v15, v32, v7 row_newbcast:12 row_mask:0xf bank_mask:0xf
    s_waitcnt vmcnt(7)
    buffer_load_dwordx4 v[132:135], v22, s[24:27], s60 offen offset:1024 nt
    v_mfma_f32_16x16x32_bf16 v[60:63], v[12:15], v[140:143], v[60:63]
    v_and_b32_dpp v8, v32, v4 row_newbcast:2 row_mask:0xf bank_mask:0xf
    v_and_b32_dpp v9, v32, v5 row_newbcast:2 row_mask:0xf bank_mask:0xf
    v_and_b32_dpp v10, v32, v6 row_newbcast:2 row_mask:0xf bank_mask:0xf
    v_and_b32_dpp v11, v32, v7 row_newbcast:2 row_mask:0xf bank_mask:0xf
    s_waitcnt vmcnt(7)
    buffer_load_dwordx4 v[136:139], v22, s[24:27], s60 offen offset:2048 nt
    v_mfma_f32_16x16x32_bf16 v[60:63], v[8:11], v[144:147], v[60:63]
    v_and_b32_dpp v12, v32, v4 row_newbcast:10 row_mask:0xf bank_mask:0xf
    v_and_b32_dpp v13, v32, v5 row_newbcast:10 row_mask:0xf bank_mask:0xf
    v_and_b32_dpp v14, v32, v6 row_newbcast:10 row_mask:0xf bank_mask:0xf
    v_and_b32_dpp v15, v32, v7 row_newbcast:10 row_mask:0xf bank_mask:0xf
    s_waitcnt vmcnt(7)
    buffer_load_dwordx4 v[140:143], v22, s[24:27], s60 offen offset:3072 nt
    s_or_b32 s60, s60, 0x13000
    s_add_u32 s60, s60, 0x4000
    s_and_b32 s60, s60, 0xecfff
    s_add_u32 s63, s63, 1
    s_cmp_lg_u32 s63, s40
    s_cselect_b64 s[24:25], s[24:25], s[28:29]
    s_cselect_b64 s[28:29], s[28:29], s[30:31]
    s_cselect_b64 s[30:31], s[30:31], s[36:37]
    s_cselect_b64 s[36:37], s[36:37], s[42:43]
    s_cselect_b32 s3, 0, s41
    s_cselect_b32 s41, s41, 32
    s_add_u32 s40, s40, s3
    v_mfma_f32_16x16x32_bf16 v[60:63], v[12:15], v[148:151], v[60:63]
    v_and_b32_dpp v8, v32, v4 row_newbcast:6 row_mask:0xf bank_mask:0xf
    v_and_b32_dpp v9, v32, v5 row_newbcast:6 row_mask:0xf bank_mask:0xf
    v_and_b32_dpp v10, v32, v6 row_newbcast:6 row_mask:0xf bank_mask:0xf
    v_and_b32_dpp v11, v32, v7 row_newbcast:6 row_mask:0xf bank_mask:0xf
    s_waitcnt vmcnt(7)
    buffer_load_dwordx4 v[144:147], v22, s[24:27], s60 offen nt
    v_mfma_f32_16x16x32_bf16 v[60:63], v[8:11], v[152:155], v[60:63]
    v_and_b32_dpp v12, v32, v4 row_newbcast:14 row_mask:0xf bank_mask:0xf
    v_and_b32_dpp v13, v32, v5 row_newbcast:14 row_mask:0xf bank_mask:0xf
    v_and_b32_dpp v14, v32, v6 row_newbcast:14 row_mask:0xf bank_mask:0xf
    v_and_b32_dpp v15, v32, v7 row_newbcast:14 row_mask:0xf bank_mask:0xf
    s_waitcnt vmcnt(7)
    buffer_load_dwordx4 v[148:151], v22, s[24:27], s60 offen offset:1024 nt
    v_mfma_f32_16x16x32_bf16 v[60:63], v[12:15], v[156:159], v[60:63]
    v_and_b32_dpp v8, v32, v4 row_newbcast:1 row_mask:0xf bank_mask:0xf
    v_and_b32_dpp v9, v32, v5 row_newbcast:1 row_mask:0xf bank_mask:0xf
    v_and_b32_dpp v10, v32, v6 row_newbcast:1 row_mask:0xf bank_mask:0xf
    v_and_b32_dpp v11, v32, v7 row_newbcast:1 row_mask:0xf bank_mask:0xf
    s_waitcnt vmcnt(7)
    buffer_load_dwordx4 v[152:155], v22, s[24:27], s60 offen offset:2048 nt
    v_mfma_f32_16x16x32_bf16 v[60:63], v[8:11], v[160:163], v[60:63]
    v_and_b32_dpp v12, v32, v4 row_newbcast:9 row_mask:0xf bank_mask:0xf
    v_and_b32_dpp v13, v32, v5 row_newbcast:9 row_mask:0xf bank_mask:0xf
    v_and_b32_dpp v14, v32, v6 row_newbcast:9 row_mask:0xf bank_mask:0xf
    v_and_b32_dpp v15, v32, v7 row_newbcast:9 row_mask:0xf bank_mask:0xf
    s_waitcnt vmcnt(7)
    buffer_load_dwordx4 v[156:159], v22, s[24:27], s60 offen offset:3072 nt
    s_or_b32 s60, s60, 0x13000
    s_add_u32 s60, s60, 0x4000
    s_and_b32 s60, s60, 0xecfff
    s_add_u32 s63, s63, 1
    s_cmp_lg_u32 s63, s40
    s_cselect_b64 s[24:25], s[24:25], s[28:29]
    s_cselect_b64 s[28:29], s[28:29], s[30:31]
    s_cselect_b64 s[30:31], s[30:31], s[36:37]
    s_cselect_b64 s[36:37], s[36:37], s[42:43]
    s_cselect_b32 s3, 0, s41
    s_cselect_b32 s41, s41, 32
    s_add_u32 s40, s40, s3
    v_mfma_f32_16x16x32_bf16 v[60:63], v[12:15], v[164:167], v[60:63]
    v_and_b32_dpp v8, v32, v4 row_newbcast:5 row_mask:0xf bank_mask:0xf
    v_and_b32_dpp v9, v32, v5 row_newbcast:5 row_mask:0xf bank_mask:0xf
    v_and_b32_dpp v10, v32, v6 row_newbcast:5 row_mask:0xf bank_mask:0xf
    v_and_b32_dpp v11, v32, v7 row_newbcast:5 row_mask:0xf bank_mask:0xf
    s_waitcnt vmcnt(7)
    buffer_load_dwordx4 v[160:163], v22, s[24:27], s60 offen nt
    v_mfma_f32_16x16x32_bf16 v[60:63], v[8:11], v[168:171], v[60:63]
    v_and_b32_dpp v12, v32, v4 row_newbcast:13 row_mask:0xf bank_mask:0xf
    v_and_b32_dpp v13, v32, v5 row_newbcast:13 row_mask:0xf bank_mask:0xf
    v_and_b32_dpp v14, v32, v6 row_newbcast:13 row_mask:0xf bank_mask:0xf
    v_and_b32_dpp v15, v32, v7 row_newbcast:13 row_mask:0xf bank_mask:0xf
    s_waitcnt vmcnt(7)
    buffer_load_dwordx4 v[164:167], v22, s[24:27], s60 offen offset:1024 nt
    v_mfma_f32_16x16x32_bf16 v[60:63], v[12:15], v[172:175], v[60:63]
    v_and_b32_dpp v8, v32, v4 row_newbcast:3 row_mask:0xf bank_mask:0xf
    v_and_b32_dpp v9, v32, v5 row_newbcast:3 row_mask:0xf bank_mask:0xf
    v_and_b32_dpp v10, v32, v6 row_newbcast:3 row_mask:0xf bank_mask:0xf
    v_and_b32_dpp v11, v32, v7 row_newbcast:3 row_mask:0xf bank_mask:0xf
    s_waitcnt vmcnt(7)
    buffer_load_dwordx4 v[168:171], v22, s[24:27], s60 offen offset:2048 nt
    v_mfma_f32_16x16x32_bf16 v[60:63], v[8:11], v[176:179], v[60:63]
    v_and_b32_dpp v12, v32, v4 row_newbcast:11 row_mask:0xf bank_mask:0xf
    v_and_b32_dpp v13, v32, v5 row_newbcast:11 row_mask:0xf bank_mask:0xf
    v_and_b32_dpp v14, v32, v6 row_newbcast:11 row_mask:0xf bank_mask:0xf
    v_and_b32_dpp v15, v32, v7 row_newbcast:11 row_mask:0xf bank_mask:0xf
    s_waitcnt vmcnt(7)
    buffer_load_dwordx4 v[172:175], v22, s[24:27], s60 offen offset:3072 nt
    s_or_b32 s60, s60, 0x13000
    s_add_u32 s60, s60, 0x4000
    s_and_b32 s60, s60, 0xecfff
    s_add_u32 s63, s63, 1
    s_cmp_lg_u32 s63, s40
    s_cselect_b64 s[24:25], s[24:25], s[28:29]
    s_cselect_b64 s[28:29], s[28:29], s[30:31]
    s_cselect_b64 s[30:31], s[30:31], s[36:37]
    s_cselect_b64 s[36:37], s[36:37], s[42:43]
    s_cselect_b32 s3, 0, s41
    s_cselect_b32 s41, s41, 32
    s_add_u32 s40, s40, s3
    v_mfma_f32_16x16x32_bf16 v[60:63], v[12:15], v[180:183], v[60:63]
    v_and_b32_dpp v8, v32, v4 row_newbcast:7 row_mask:0xf bank_mask:0xf
    v_and_b32_dpp v9, v32, v5 row_newbcast:7 row_mask:0xf bank_mask:0xf
    v_and_b32_dpp v10, v32, v6 row_newbcast:7 row_mask:0xf bank_mask:0xf
    v_and_b32_dpp v11, v32, v7 row_newbcast:7 row_mask:0xf bank_mask:0xf
    s_nop 1
    v_mfma_f32_16x16x32_bf16 v[60:63], v[8:11], v[184:187], v[60:63]
    v_and_b32_dpp v12, v32, v4 row_newbcast:15 row_mask:0xf bank_mask:0xf
    v_and_b32_dpp v13, v32, v5 row_newbcast:15 row_mask:0xf bank_mask:0xf
    v_and_b32_dpp v14, v32, v6 row_newbcast:15 row_mask:0xf bank_mask:0xf
    v_and_b32_dpp v15, v32, v7 row_newbcast:15 row_mask:0xf bank_mask:0xf
    s_nop 1
    v_mfma_f32_16x16x32_bf16 v[60:63], v[12:15], v[188:191], v[60:63]
    s_waitcnt vmcnt(7)
    buffer_load_dwordx4 v[176:179], v22, s[24:27], s60 offen nt
    s_nop 5
    v_mul_f32 v60, v60, v20
    v_mul_f32 v61, v61, v20
    v_mul_f32 v62, v62, v20
    v_mul_f32 v63, v63, v20
    s_mov_b32 exec_hi, 0
    ds_write_b128 v16, v[60:63] offset:0
    s_mov_b64 exec, -1
    s_waitcnt vmcnt(7)
    buffer_load_dwordx4 v[180:183], v22, s[24:27], s60 offen offset:1024 nt
    s_waitcnt lgkmcnt(0)
    s_mov_b64 exec, 1
    ds_add_u32 v24, v23 offset:4232
    s_mov_b64 exec, -1
    v_mov_b32 v32, v68
    v_mov_b32 v20, v69
    v_mov_b32 v60, v64
    v_mov_b32 v61, v65
    v_mov_b32 v62, v66
    v_mov_b32 v63, v67
    s_waitcnt vmcnt(7)
    buffer_load_dwordx4 v[184:187], v22, s[24:27], s60 offen offset:2048 nt
    s_mov_b32 s70, 0
L_m103:
    ds_read_b128 v[40:43], v24 offset:4096
    ds_read_b128 v[44:47], v24 offset:4112
    s_add_u32 s70, s70, 1
    s_waitcnt lgkmcnt(0)
    v_min3_u32 v18, v41, v43, v45
    v_min3_u32 v18, v18, v47, v47
    s_cmp_ge_u32 s70, 0x100000
    v_readfirstlane_b32 s3, v18
    s_cbranch_scc1 L_m103_ok
    s_cmp_lg_u32 s3, 0
    s_cbranch_scc0 L_m103
L_m103_ok:
    s_waitcnt vmcnt(7)
    buffer_load_dwordx4 v[188:191], v22, s[24:27], s60 offen offset:3072 nt
    s_or_b32 s60, s60, 0x13000
    s_add_u32 s60, s60, 0x4000
    s_and_b32 s60, s60, 0xecfff
    s_add_u32 s63, s63, 1
    s_cmp_lg_u32 s63, s40
    s_cselect_b64 s[24:25], s[24:25], s[28:29]
    s_cselect_b64 s[28:29], s[28:29], s[30:31]
    s_cselect_b64 s[30:31], s[30:31], s[36:37]
    s_cselect_b64 s[36:37], s[36:37], s[42:43]
    s_cselect_b32 s3, 0, s41
    s_cselect_b32 s41, s41, 32
    s_add_u32 s40, s40, s3
    v_max3_f32 v17, v40, v42, v44
    v_max_f32 v17, v17, v46
    v_sub_f32 v20, v20, v17
    v_exp_f32 v20, v20
    v_and_b32_dpp v8, v32, v4 row_newbcast:0 row_mask:0xf bank_mask:0xf
    v_and_b32_dpp v9, v32, v5 row_newbcast:0 row_mask:0xf bank_mask:0xf
    v_and_b32_dpp v10, v32, v6 row_newbcast:0 row_mask:0xf bank_mask:0xf
    v_and_b32_dpp v11, v32, v7 row_newbcast:0 row_mask:0xf bank_mask:0xf
    s_waitcnt lgkmcnt(0)
    s_add_u32 s39, s39, 16
    v_readfirstlane_b32 s74, v70
    v_mov_b32 v71, s39
    ds_write_b32 v25, v71 offset:4256
    ds_read_b32 v70, v25 offset:4272
    v_mfma_f32_16x16x32_bf16 v[60:63], v[8:11], v[128:131], v[60:63]
    v_and_b32_dpp v12, v32, v4 row_newbcast:8 row_mask:0xf bank_mask:0xf
    v_and_b32_dpp v13, v32, v5 row_newbcast:8 row_mask:0xf bank_mask:0xf
    v_and_b32_dpp v14, v32, v6 row_newbcast:8 row_mask:0xf bank_mask:0xf
    v_and_b32_dpp v15, v32, v7 row_newbcast:8 row_mask:0xf bank_mask:0xf
    s_nop 1
    v_mfma_f32_16x16x32_bf16 v[60:63], v[12:15], v[132:135], v[60:63]
    v_and_b32_dpp v8, v32, v4 row_newbcast:4 row_mask:0xf bank_mask:0xf
    v_and_b32_dpp v9, v32, v5 row_newbcast:4 row_mask:0xf bank_mask:0xf
    v_and_b32_dpp v10, v32, v6 row_newbcast:4 row_mask:0xf bank_mask:0xf
    v_and_b32_dpp v11, v32, v7 row_newbcast:4 row_mask:0xf bank_mask:0xf
    s_nop 1
    v_mfma_f32_16x16x32_bf16 v[60:63], v[8:11], v[136:139], v[60:63]
    v_and_b32_dpp v12, v32, v4 row_newbcast:12 row_mask:0xf bank_mask:0xf
    v_and_b32_dpp v13, v32, v5 row_newbcast:12 row_mask:0xf bank_mask:0xf
    v_and_b32_dpp v14, v32, v6 row_newbcast:12 row_mask:0xf bank_mask:0xf
    v_and_b32_dpp v15, v32, v7 row_newbcast:12 row_mask:0xf bank_mask:0xf
    s_nop 1
    v_mfma_f32_16x16x32_bf16 v[60:63], v[12:15], v[140:143], v[60:63]
    v_and_b32_dpp v8, v32, v4 row_newbcast:2 row_mask:0xf bank_mask:0xf
    v_and_b32_dpp v9, v32, v5 row_newbcast:2 row_mask:0xf bank_mask:0xf
    v_and_b32_dpp v10, v32, v6 row_newbcast:2 row_mask:0xf bank_mask:0xf
    v_and_b32_dpp v11, v32, v7 row_newbcast:2 row_mask:0xf bank_mask:0xf
    s_nop 1
    v_mfma_f32_16x16x32_bf16 v[60:63], v[8:11], v[144:147], v[60:63]
    v_and_b32_dpp v12, v32, v4 row_newbcast:10 row_mask:0xf bank_mask:0xf
    v_and_b32_dpp v13, v32, v5 row_newbcast:10 row_mask:0xf bank_mask:0xf
    v_and_b32_dpp v14, v32, v6 row_newbcast:10 row_mask:0xf bank_mask:0xf
    v_and_b32_dpp v15, v32, v7 row_newbcast:10 row_mask:0xf bank_mask:0xf
    s_nop 1
    v_mfma_f32_16x16x32_bf16 v[60:63], v[12:15], v[148:151], v[60:63]
    v_and_b32_dpp v8, v32, v4 row_newbcast:6 row_mask:0xf bank_mask:0xf
    v_and_b32_dpp v9, v32, v5 row_newbcast:6 row_mask:0xf bank_mask:0xf
    v_and_b32_dpp v10, v32, v6 row_newbcast:6 row_mask:0xf bank_mask:0xf
    v_and_b32_dpp v11, v32, v7 row_newbcast:6 row_mask:0xf bank_mask:0xf
    s_nop 1
    v_mfma_f32_16x16x32_bf16 v[60:63], v[8:11], v[152:155], v[60:63]
    v_and_b32_dpp v12, v32, v4 row_newbcast:14 row_mask:0xf bank_mask:0xf
    v_and_b32_dpp v13, v32, v5 row_newbcast:14 row_mask:0xf bank_mask:0xf
    v_and_b32_dpp v14, v32, v6 row_newbcast:14 row_mask:0xf bank_mask:0xf
    v_and_b32_dpp v15, v32, v7 row_newbcast:14 row_mask:0xf bank_mask:0xf
    s_nop 1
    v_mfma_f32_16x16x32_bf16 v[60:63], v[12:15], v[156:159], v[60:63]
    v_and_b32_dpp v8, v32, v4 row_newbcast:1 row_mask:0xf bank_mask:0xf
    v_and_b32_dpp v9, v32, v5 row_newbcast:1 row_mask:0xf bank_mask:0xf
    v_and_b32_dpp v10, v32, v6 row_newbcast:1 row_mask:0xf bank_mask:0xf
    v_and_b32_dpp v11, v32, v7 row_newbcast:1 row_mask:0xf bank_mask:0xf
    s_waitcnt vmcnt(7)
    s_nop 0
    v_mfma_f32_16x16x32_bf16 v[60:63], v[8:11], v[160:163], v[60:63]
    v_and_b32_dpp v12, v32, v4 row_newbcast:9 row_mask:0xf bank_mask:0xf
    v_and_b32_dpp v13, v32, v5 row_newbcast:9 row_mask:0xf bank_mask:0xf
    v_and_b32_dpp v14, v32, v6 row_newbcast:9 row_mask:0xf bank_mask:0xf
    v_and_b32_dpp v15, v32, v7 row_newbcast:9 row_mask:0xf bank_mask:0xf
    s_waitcnt vmcnt(6)
    s_nop 0
    v_mfma_f32_16x16x32_bf16 v[60:63], v[12:15], v[164:167], v[60:63]
    v_and_b32_dpp v8, v32, v4 row_newbcast:5 row_mask:0xf bank_mask:0xf
    v_and_b32_dpp v9, v32, v5 row_newbcast:5 row_mask:0xf bank_mask:0xf
    v_and_b32_dpp v10, v32, v6 row_newbcast:5 row_mask:0xf bank_mask:0xf
    v_and_b32_dpp v11, v32, v7 row_newbcast:5 row_mask:0xf bank_mask:0xf
    s_waitcnt vmcnt(5)
    s_nop 0
    v_mfma_f32_16x16x32_bf16 v[60:63], v[8:11], v[168:171], v[60:63]
    v_and_b32_dpp v12, v32, v4 row_newbcast:13 row_mask:0xf bank_mask:0xf
    v_and_b32_dpp v13, v32, v5 row_newbcast:13 row_mask:0xf bank_mask:0xf
    v_and_b32_dpp v14, v32, v6 row_newbcast:13 row_mask:0xf bank_mask:0xf
    v_and_b32_dpp v15, v32, v7 row_newbcast:13 row_mask:0xf bank_mask:0xf
    s_waitcnt vmcnt(4)
    s_nop 0
    v_mfma_f32_16x16x32_bf16 v[60:63], v[12:15], v[172:175], v[60:63]
    v_and_b32_dpp v8, v32, v4 row_newbcast:3 row_mask:0xf bank_mask:0xf
    v_and_b32_dpp v9, v32, v5 row_newbcast:3 row_mask:0xf bank_mask:0xf
    v_and_b32_dpp v10, v32, v6 row_newbcast:3 row_mask:0xf bank_mask:0xf
    v_and_b32_dpp v11, v32, v7 row_newbcast:3 row_mask:0xf bank_mask:0xf
    s_waitcnt vmcnt(3)
    s_nop 0
    v_mfma_f32_16x16x32_bf16 v[60:63], v[8:11], v[176:179], v[60:63]
    v_and_b32_dpp v12, v32, v4 row_newbcast:11 row_mask:0xf bank_mask:0xf
    v_and_b32_dpp v13, v32, v5 row_newbcast:11 row_mask:0xf bank_mask:0xf
    v_and_b32_dpp v14, v32, v6 row_newbcast:11 row_mask:0xf bank_mask:0xf
    v_and_b32_dpp v15, v32, v7 row_newbcast:11 row_mask:0xf bank_mask:0xf
    s_waitcnt vmcnt(2)
    s_nop 0
    v_mfma_f32_16x16x32_bf16 v[60:63], v[12:15], v[180:183], v[60:63]
    v_and_b32_dpp v8, v32, v4 row_newbcast:7 row_mask:0xf bank_mask:0xf
    v_and_b32_dpp v9, v32, v5 row_newbcast:7 row_mask:0xf bank_mask:0xf
    v_and_b32_dpp v10, v32, v6 row_newbcast:7 row_mask:0xf bank_mask:0xf
    v_and_b32_dpp v11, v32, v7 row_newbcast:7 row_mask:0xf bank_mask:0xf
    s_waitcnt vmcnt(1)
    s_nop 0
    v_mfma_f32_16x16x32_bf16 v[60:63], v[8:11], v[184:187], v[60:63]
    v_and_b32_dpp v12, v32, v4 row_newbcast:15 row_mask:0xf bank_mask:0xf
    v_and_b32_dpp v13, v32, v5 row_newbcast:15 row_mask:0xf bank_mask:0xf
    v_and_b32_dpp v14, v32, v6 row_newbcast:15 row_mask:0xf bank_mask:0xf
    v_and_b32_dpp v15, v32, v7 row_newbcast:15 row_mask:0xf bank_mask:0xf
    s_waitcnt vmcnt(0)
    s_nop 0
    v_mfma_f32_16x16x32_bf16 v[60:63], v[12:15], v[188:191], v[60:63]
    s_nop 7
L_last:
    v_mul_f32 v60, v60, v20
    v_mul_f32 v61, v61, v20
    v_mul_f32 v62, v62, v20
    v_mul_f32 v63, v63, v20
    s_mov_b32 exec_hi, 0
    ds_write_b128 v16, v[60:63] offset:2048
    s_mov_b64 exec, -1
    s_waitcnt lgkmcnt(0)
    s_barrier
    s_endpgm
L_helper:
    s_sub_u32 s39, s56, 4
    s_mov_b32 s34, 0x500000
    s_mov_b32 s35, 0x20000
    s_mov_b32 s42, 0x1400
    s_mov_b32 s43, 0x20000
    v_lshlrev_b32 v17, 4, v3
    v_lshl_add_u32 v56, v2, 15, v17
    v_mul_u32_u24 v57, 1280, v2
    v_add_u32 v57, v57, v17
    v_lshl_add_u32 v58, v3, 2, v2
    v_lshlrev_b32 v58, 3, v58
    s_mul_i32 s38, s58, 160
    s_add_u32 s38, s38, s39
    s_lshl_b32 s61, s38, 13
    s_lshl_b32 s38, s38, 1
    s_lshl_b32 s3, s57, 8
    s_add_u32 s61, s61, s3
    v_mov_b32 v59, 0
    v_mov_b32 v60, 1
    v_lshrrev_b32 v18, 2, v1
    s_waitcnt lgkmcnt(0)
    s_cmp_eq_u32 s59, 0
    s_cselect_b64 s[32:33], s[10:11], s[20:21]
    s_cselect_b64 s[40:41], s[4:5], s[14:15]
    s_cselect_b64 s[30:31], s[12:13], s[22:23]
    buffer_load_ushort v28, v58, s[40:43], s38 offen
    buffer_load_ushort v29, v58, s[40:43], s38 offen offset:1280
    buffer_load_ushort v30, v58, s[40:43], s38 offen offset:2560
    buffer_load_ushort v31, v58, s[40:43], s38 offen offset:3840
    buffer_load_dwordx4 v[64:67], v56, s[32:35], s61 offen nt
    s_add_u32 s61, s61, 0x20000
    buffer_load_dwordx4 v[68:71], v56, s[32:35], s61 offen nt
    s_add_u32 s61, s61, 0x20000
    buffer_load_dwordx4 v[72:75], v56, s[32:35], s61 offen nt
    s_add_u32 s61, s61, 0x20000
    buffer_load_dwordx4 v[76:79], v56, s[32:35], s61 offen nt
    s_add_u32 s61, s61, 0x20000
    ds_write_b32 v18, v59 offset:4096
    s_waitcnt lgkmcnt(0)
    s_barrier
    buffer_load_dwordx4 v[80:83], v56, s[32:35], s61 offen nt
    s_add_u32 s61, s61, 0x20000
    buffer_load_dwordx4 v[84:87], v56, s[32:35], s61 offen nt
    s_add_u32 s61, s61, 0x20000
    buffer_load_dwordx4 v[88:91], v56, s[32:35], s61 offen nt
    s_add_u32 s61, s61, 0x20000
    buffer_load_dwordx4 v[92:95], v56, s[32:35], s61 offen nt
    s_add_u32 s61, s61, 0x20000
    buffer_load_dwordx4 v[96:99], v56, s[32:35], s61 offen nt
    s_add_u32 s61, s61, 0x20000
    buffer_load_dwordx4 v[100:103], v56, s[32:35], s61 offen nt
    s_add_u32 s61, s61, 0x20000
    s_load_dword s76, s[50:51], s78
    s_mov_b32 s44, s50
    s_mov_b32 s45, s51
    s_lshl_b32 s37, s57, 7
    s_lshl_b32 s3, s39, 5
    s_add_u32 s37, s37, s3
    s_mul_i32 s37, s37, 1280
    v_and_b32 v17, 1, v3
    v_lshlrev_b32 v17, 4, v17
    v_mov_b32 v18, 0xffff
    v_lshlrev_b32 v17, v17, v18
    v_lshrrev_b32 v18, 1, v3
    v_and_b32 v18, 3, v18
    v_cmp_eq_u32 vcc, 0, v18
    s_nop 1
    v_cndmask_b32_e32 v4, 0, v17, vcc
    v_cmp_eq_u32 vcc, 1, v18
    s_nop 1
    v_cndmask_b32_e32 v5, 0, v17, vcc
    v_cmp_eq_u32 vcc, 2, v18
    s_nop 1
    v_cndmask_b32_e32 v6, 0, v17, vcc
    v_cmp_eq_u32 vcc, 3, v18
    s_nop 1
    v_cndmask_b32_e32 v7, 0, v17, vcc
    v_lshlrev_b32 v17, 5, v3
    v_lshl_add_u32 v17, v2, 4, v17
    s_and_b32 s3, s56, 3
    s_lshl_b32 s3, s3, 9
    v_add_u32 v16, s3, v17
    v_and_b32 v18, 7, v3
    v_lshl_add_u32 v18, v18, 2, v2
    v_lshlrev_b32 v18, 2, v18
    s_lshl_b32 s3, s39, 7
    v_add_u32 v18, s3, v18
    s_mul_i32 s3, s39, 2048
    v_add_u32 v19, s3, v16
    v_subrev_u32 v17, 256, v0
    v_lshlrev_b32 v20, 4, v17
    v_lshrrev_b32 v21, 3, v17
    v_lshlrev_b32 v21, 12, v21
    v_and_b32 v22, 7, v17
    v_lshl_add_u32 v21, v22, 4, v21
    v_cmp_gt_u32 vcc, 160, v17
    s_nop 0
    s_mov_b64 s[74:75], vcc
    s_lshl_b32 s3, s59, 2
    s_add_u32 s3, s3, s58
    s_mul_i32 s72, s3, 81920
    s_lshl_b32 s3, s57, 7
    s_add_u32 s72, s72, s3
    s_lshl_b32 s28, s2, 10
    s_add_u32 s28, s28, 1048576
    s_xor_b32 s29, s28, 0x2000
    s_waitcnt lgkmcnt(0)
    s_add_u32 s77, s76, 1
    s_and_b32 s76, s77, 0xff
    v_mov_b32 v22, 0xffffff00
    v_mov_b32 v23, s76
    s_getreg_b32 s26, hwreg(HW_REG_XCC_ID, 0, 3)
    s_lshl_b32 s24, s26, 10
    s_add_u32 s24, s24, 1843200
    s_lshl_b32 s3, s2, 2
    s_add_u32 s25, s24, s3
    s_andn2_b32 s3, s3, 0x320
    s_add_u32 s24, s24, s3
    v_bfe_u32 v229, v1, 5, 2
    v_lshlrev_b32 v229, 8, v229
    v_and_b32 v224, 16, v1
    v_lshl_add_u32 v229, v224, 1, v229
    s_cmp_eq_u32 s39, 0
    s_cselect_b32 s3, s25, 0x40000000
    v_mov_b32 v224, s77
    s_mov_b64 exec, 1
    buffer_store_dword v224, v59, s[44:47], s3 offen
    s_mov_b64 exec, -1
    s_waitcnt vmcnt(11)
    v_lshl_or_b32 v28, v28, 16, v28
    v_lshl_or_b32 v29, v29, 16, v29
    v_lshl_or_b32 v30, v30, 16, v30
    v_lshl_or_b32 v31, v31, 16, v31
    v_and_b32_dpp v8, v28, v4 row_newbcast:0 row_mask:0xf bank_mask:0x3
    v_and_b32_dpp v9, v28, v5 row_newbcast:0 row_mask:0xf bank_mask:0x3
    v_and_b32_dpp v10, v28, v6 row_newbcast:0 row_mask:0xf bank_mask:0x3
    v_and_b32_dpp v11, v28, v7 row_newbcast:0 row_mask:0xf bank_mask:0x3
    v_and_b32_dpp v8, v29, v4 row_newbcast:0 row_mask:0xf bank_mask:0xc
    v_and_b32_dpp v9, v29, v5 row_newbcast:0 row_mask:0xf bank_mask:0xc
    v_and_b32_dpp v10, v29, v6 row_newbcast:0 row_mask:0xf bank_mask:0xc
    v_and_b32_dpp v11, v29, v7 row_newbcast:0 row_mask:0xf bank_mask:0xc
    v_and_b32_dpp v12, v30, v4 row_newbcast:0 row_mask:0xf bank_mask:0x3
    v_and_b32_dpp v13, v30, v5 row_newbcast:0 row_mask:0xf bank_mask:0x3
    v_and_b32_dpp v14, v30, v6 row_newbcast:0 row_mask:0xf bank_mask:0x3
    v_and_b32_dpp v15, v30, v7 row_newbcast:0 row_mask:0xf bank_mask:0x3
    v_and_b32_dpp v12, v31, v4 row_newbcast:0 row_mask:0xf bank_mask:0xc
    v_and_b32_dpp v13, v31, v5 row_newbcast:0 row_mask:0xf bank_mask:0xc
    v_and_b32_dpp v14, v31, v6 row_newbcast:0 row_mask:0xf bank_mask:0xc
    v_and_b32_dpp v15, v31, v7 row_newbcast:0 row_mask:0xf bank_mask:0xc
    s_waitcnt vmcnt(10)
    v_mfma_f32_16x16x32_bf16 v[36:39], v[8:11], v[64:67], 0
    v_mfma_f32_16x16x32_bf16 v[40:43], v[12:15], v[64:67], 0
    v_and_b32_dpp v8, v28, v4 row_newbcast:1 row_mask:0xf bank_mask:0x3
    v_and_b32_dpp v9, v28, v5 row_newbcast:1 row_mask:0xf bank_mask:0x3
    v_and_b32_dpp v10, v28, v6 row_newbcast:1 row_mask:0xf bank_mask:0x3
    v_and_b32_dpp v11, v28, v7 row_newbcast:1 row_mask:0xf bank_mask:0x3
    v_and_b32_dpp v8, v29, v4 row_newbcast:1 row_mask:0xf bank_mask:0xc
    v_and_b32_dpp v9, v29, v5 row_newbcast:1 row_mask:0xf bank_mask:0xc
    v_and_b32_dpp v10, v29, v6 row_newbcast:1 row_mask:0xf bank_mask:0xc
    v_and_b32_dpp v11, v29, v7 row_newbcast:1 row_mask:0xf bank_mask:0xc
    v_and_b32_dpp v12, v30, v4 row_newbcast:1 row_mask:0xf bank_mask:0x3
    v_and_b32_dpp v13, v30, v5 row_newbcast:1 row_mask:0xf bank_mask:0x3
    v_and_b32_dpp v14, v30, v6 row_newbcast:1 row_mask:0xf bank_mask:0x3
    v_and_b32_dpp v15, v30, v7 row_newbcast:1 row_mask:0xf bank_mask:0x3
    v_and_b32_dpp v12, v31, v4 row_newbcast:1 row_mask:0xf bank_mask:0xc
    v_and_b32_dpp v13, v31, v5 row_newbcast:1 row_mask:0xf bank_mask:0xc
    v_and_b32_dpp v14, v31, v6 row_newbcast:1 row_mask:0xf bank_mask:0xc
    v_and_b32_dpp v15, v31, v7 row_newbcast:1 row_mask:0xf bank_mask:0xc
    s_waitcnt vmcnt(9)
    v_mfma_f32_16x16x32_bf16 v[36:39], v[8:11], v[68:71], v[36:39]
    v_mfma_f32_16x16x32_bf16 v[40:43], v[12:15], v[68:71], v[40:43]
    v_and_b32_dpp v8, v28, v4 row_newbcast:2 row_mask:0xf bank_mask:0x3
    v_and_b32_dpp v9, v28, v5 row_newbcast:2 row_mask:0xf bank_mask:0x3
    v_and_b32_dpp v10, v28, v6 row_newbcast:2 row_mask:0xf bank_mask:0x3
    v_and_b32_dpp v11, v28, v7 row_newbcast:2 row_mask:0xf bank_mask:0x3
    v_and_b32_dpp v8, v29, v4 row_newbcast:2 row_mask:0xf bank_mask:0xc
    v_and_b32_dpp v9, v29, v5 row_newbcast:2 row_mask:0xf bank_mask:0xc
    v_and_b32_dpp v10, v29, v6 row_newbcast:2 row_mask:0xf bank_mask:0xc
    v_and_b32_dpp v11, v29, v7 row_newbcast:2 row_mask:0xf bank_mask:0xc
    v_and_b32_dpp v12, v30, v4 row_newbcast:2 row_mask:0xf bank_mask:0x3
    v_and_b32_dpp v13, v30, v5 row_newbcast:2 row_mask:0xf bank_mask:0x3
    v_and_b32_dpp v14, v30, v6 row_newbcast:2 row_mask:0xf bank_mask:0x3
    v_and_b32_dpp v15, v30, v7 row_newbcast:2 row_mask:0xf bank_mask:0x3
    v_and_b32_dpp v12, v31, v4 row_newbcast:2 row_mask:0xf bank_mask:0xc
    v_and_b32_dpp v13, v31, v5 row_newbcast:2 row_mask:0xf bank_mask:0xc
    v_and_b32_dpp v14, v31, v6 row_newbcast:2 row_mask:0xf bank_mask:0xc
    v_and_b32_dpp v15, v31, v7 row_newbcast:2 row_mask:0xf bank_mask:0xc
    s_waitcnt vmcnt(8)
    v_mfma_f32_16x16x32_bf16 v[36:39], v[8:11], v[72:75], v[36:39]
    v_mfma_f32_16x16x32_bf16 v[40:43], v[12:15], v[72:75], v[40:43]
    v_and_b32_dpp v8, v28, v4 row_newbcast:3 row_mask:0xf bank_mask:0x3
    v_and_b32_dpp v9, v28, v5 row_newbcast:3 row_mask:0xf bank_mask:0x3
    v_and_b32_dpp v10, v28, v6 row_newbcast:3 row_mask:0xf bank_mask:0x3
    v_and_b32_dpp v11, v28, v7 row_newbcast:3 row_mask:0xf bank_mask:0x3
    v_and_b32_dpp v8, v29, v4 row_newbcast:3 row_mask:0xf bank_mask:0xc
    v_and_b32_dpp v9, v29, v5 row_newbcast:3 row_mask:0xf bank_mask:0xc
    v_and_b32_dpp v10, v29, v6 row_newbcast:3 row_mask:0xf bank_mask:0xc
    v_and_b32_dpp v11, v29, v7 row_newbcast:3 row_mask:0xf bank_mask:0xc
    v_and_b32_dpp v12, v30, v4 row_newbcast:3 row_mask:0xf bank_mask:0x3
    v_and_b32_dpp v13, v30, v5 row_newbcast:3 row_mask:0xf bank_mask:0x3
    v_and_b32_dpp v14, v30, v6 row_newbcast:3 row_mask:0xf bank_mask:0x3
    v_and_b32_dpp v15, v30, v7 row_newbcast:3 row_mask:0xf bank_mask:0x3
    v_and_b32_dpp v12, v31, v4 row_newbcast:3 row_mask:0xf bank_mask:0xc
    v_and_b32_dpp v13, v31, v5 row_newbcast:3 row_mask:0xf bank_mask:0xc
    v_and_b32_dpp v14, v31, v6 row_newbcast:3 row_mask:0xf bank_mask:0xc
    v_and_b32_dpp v15, v31, v7 row_newbcast:3 row_mask:0xf bank_mask:0xc
    s_waitcnt vmcnt(7)
    v_mfma_f32_16x16x32_bf16 v[36:39], v[8:11], v[76:79], v[36:39]
    v_mfma_f32_16x16x32_bf16 v[40:43], v[12:15], v[76:79], v[40:43]
    v_and_b32_dpp v8, v28, v4 row_newbcast:4 row_mask:0xf bank_mask:0x3
    v_and_b32_dpp v9, v28, v5 row_newbcast:4 row_mask:0xf bank_mask:0x3
    v_and_b32_dpp v10, v28, v6 row_newbcast:4 row_mask:0xf bank_mask:0x3
    v_and_b32_dpp v11, v28, v7 row_newbcast:4 row_mask:0xf bank_mask:0x3
    v_and_b32_dpp v8, v29, v4 row_newbcast:4 row_mask:0xf bank_mask:0xc
    v_and_b32_dpp v9, v29, v5 row_newbcast:4 row_mask:0xf bank_mask:0xc
    v_and_b32_dpp v10, v29, v6 row_newbcast:4 row_mask:0xf bank_mask:0xc
    v_and_b32_dpp v11, v29, v7 row_newbcast:4 row_mask:0xf bank_mask:0xc
    v_and_b32_dpp v12, v30, v4 row_newbcast:4 row_mask:0xf bank_mask:0x3
    v_and_b32_dpp v13, v30, v5 row_newbcast:4 row_mask:0xf bank_mask:0x3
    v_and_b32_dpp v14, v30, v6 row_newbcast:4 row_mask:0xf bank_mask:0x3
    v_and_b32_dpp v15, v30, v7 row_newbcast:4 row_mask:0xf bank_mask:0x3
    v_and_b32_dpp v12, v31, v4 row_newbcast:4 row_mask:0xf bank_mask:0xc
    v_and_b32_dpp v13, v31, v5 row_newbcast:4 row_mask:0xf bank_mask:0xc
    v_and_b32_dpp v14, v31, v6 row_newbcast:4 row_mask:0xf bank_mask:0xc
    v_and_b32_dpp v15, v31, v7 row_newbcast:4 row_mask:0xf bank_mask:0xc
    s_waitcnt vmcnt(6)
    v_mfma_f32_16x16x32_bf16 v[36:39], v[8:11], v[80:83], v[36:39]
    v_mfma_f32_16x16x32_bf16 v[40:43], v[12:15], v[80:83], v[40:43]
    v_and_b32_dpp v8, v28, v4 row_newbcast:5 row_mask:0xf bank_mask:0x3
    v_and_b32_dpp v9, v28, v5 row_newbcast:5 row_mask:0xf bank_mask:0x3
    v_and_b32_dpp v10, v28, v6 row_newbcast:5 row_mask:0xf bank_mask:0x3
    v_and_b32_dpp v11, v28, v7 row_newbcast:5 row_mask:0xf bank_mask:0x3
    v_and_b32_dpp v8, v29, v4 row_newbcast:5 row_mask:0xf bank_mask:0xc
    v_and_b32_dpp v9, v29, v5 row_newbcast:5 row_mask:0xf bank_mask:0xc
    v_and_b32_dpp v10, v29, v6 row_newbcast:5 row_mask:0xf bank_mask:0xc
    v_and_b32_dpp v11, v29, v7 row_newbcast:5 row_mask:0xf bank_mask:0xc
    v_and_b32_dpp v12, v30, v4 row_newbcast:5 row_mask:0xf bank_mask:0x3
    v_and_b32_dpp v13, v30, v5 row_newbcast:5 row_mask:0xf bank_mask:0x3
    v_and_b32_dpp v14, v30, v6 row_newbcast:5 row_mask:0xf bank_mask:0x3
    v_and_b32_dpp v15, v30, v7 row_newbcast:5 row_mask:0xf bank_mask:0x3
    v_and_b32_dpp v12, v31, v4 row_newbcast:5 row_mask:0xf bank_mask:0xc
    v_and_b32_dpp v13, v31, v5 row_newbcast:5 row_mask:0xf bank_mask:0xc
    v_and_b32_dpp v14, v31, v6 row_newbcast:5 row_mask:0xf bank_mask:0xc
    v_and_b32_dpp v15, v31, v7 row_newbcast:5 row_mask:0xf bank_mask:0xc
    s_waitcnt vmcnt(5)
    v_mfma_f32_16x16x32_bf16 v[36:39], v[8:11], v[84:87], v[36:39]
    v_mfma_f32_16x16x32_bf16 v[40:43], v[12:15], v[84:87], v[40:43]
    v_and_b32_dpp v8, v28, v4 row_newbcast:6 row_mask:0xf bank_mask:0x3
    v_and_b32_dpp v9, v28, v5 row_newbcast:6 row_mask:0xf bank_mask:0x3
    v_and_b32_dpp v10, v28, v6 row_newbcast:6 row_mask:0xf bank_mask:0x3
    v_and_b32_dpp v11, v28, v7 row_newbcast:6 row_mask:0xf bank_mask:0x3
    v_and_b32_dpp v8, v29, v4 row_newbcast:6 row_mask:0xf bank_mask:0xc
    v_and_b32_dpp v9, v29, v5 row_newbcast:6 row_mask:0xf bank_mask:0xc
    v_and_b32_dpp v10, v29, v6 row_newbcast:6 row_mask:0xf bank_mask:0xc
    v_and_b32_dpp v11, v29, v7 row_newbcast:6 row_mask:0xf bank_mask:0xc
    v_and_b32_dpp v12, v30, v4 row_newbcast:6 row_mask:0xf bank_mask:0x3
    v_and_b32_dpp v13, v30, v5 row_newbcast:6 row_mask:0xf bank_mask:0x3
    v_and_b32_dpp v14, v30, v6 row_newbcast:6 row_mask:0xf bank_mask:0x3
    v_and_b32_dpp v15, v30, v7 row_newbcast:6 row_mask:0xf bank_mask:0x3
    v_and_b32_dpp v12, v31, v4 row_newbcast:6 row_mask:0xf bank_mask:0xc
    v_and_b32_dpp v13, v31, v5 row_newbcast:6 row_mask:0xf bank_mask:0xc
    v_and_b32_dpp v14, v31, v6 row_newbcast:6 row_mask:0xf bank_mask:0xc
    v_and_b32_dpp v15, v31, v7 row_newbcast:6 row_mask:0xf bank_mask:0xc
    s_waitcnt vmcnt(4)
    v_mfma_f32_16x16x32_bf16 v[36:39], v[8:11], v[88:91], v[36:39]
    v_mfma_f32_16x16x32_bf16 v[40:43], v[12:15], v[88:91], v[40:43]
    v_and_b32_dpp v8, v28, v4 row_newbcast:7 row_mask:0xf bank_mask:0x3
    v_and_b32_dpp v9, v28, v5 row_newbcast:7 row_mask:0xf bank_mask:0x3
    v_and_b32_dpp v10, v28, v6 row_newbcast:7 row_mask:0xf bank_mask:0x3
    v_and_b32_dpp v11, v28, v7 row_newbcast:7 row_mask:0xf bank_mask:0x3
    v_and_b32_dpp v8, v29, v4 row_newbcast:7 row_mask:0xf bank_mask:0xc
    v_and_b32_dpp v9, v29, v5 row_newbcast:7 row_mask:0xf bank_mask:0xc
    v_and_b32_dpp v10, v29, v6 row_newbcast:7 row_mask:0xf bank_mask:0xc
    v_and_b32_dpp v11, v29, v7 row_newbcast:7 row_mask:0xf bank_mask:0xc
    v_and_b32_dpp v12, v30, v4 row_newbcast:7 row_mask:0xf bank_mask:0x3
    v_and_b32_dpp v13, v30, v5 row_newbcast:7 row_mask:0xf bank_mask:0x3
    v_and_b32_dpp v14, v30, v6 row_newbcast:7 row_mask:0xf bank_mask:0x3
    v_and_b32_dpp v15, v30, v7 row_newbcast:7 row_mask:0xf bank_mask:0x3
    v_and_b32_dpp v12, v31, v4 row_newbcast:7 row_mask:0xf bank_mask:0xc
    v_and_b32_dpp v13, v31, v5 row_newbcast:7 row_mask:0xf bank_mask:0xc
    v_and_b32_dpp v14, v31, v6 row_newbcast:7 row_mask:0xf bank_mask:0xc
    v_and_b32_dpp v15, v31, v7 row_newbcast:7 row_mask:0xf bank_mask:0xc
    s_waitcnt vmcnt(3)
    v_mfma_f32_16x16x32_bf16 v[36:39], v[8:11], v[92:95], v[36:39]
    v_mfma_f32_16x16x32_bf16 v[40:43], v[12:15], v[92:95], v[40:43]
    v_and_b32_dpp v8, v28, v4 row_newbcast:8 row_mask:0xf bank_mask:0x3
    v_and_b32_dpp v9, v28, v5 row_newbcast:8 row_mask:0xf bank_mask:0x3
    v_and_b32_dpp v10, v28, v6 row_newbcast:8 row_mask:0xf bank_mask:0x3
    v_and_b32_dpp v11, v28, v7 row_newbcast:8 row_mask:0xf bank_mask:0x3
    v_and_b32_dpp v8, v29, v4 row_newbcast:8 row_mask:0xf bank_mask:0xc
    v_and_b32_dpp v9, v29, v5 row_newbcast:8 row_mask:0xf bank_mask:0xc
    v_and_b32_dpp v10, v29, v6 row_newbcast:8 row_mask:0xf bank_mask:0xc
    v_and_b32_dpp v11, v29, v7 row_newbcast:8 row_mask:0xf bank_mask:0xc
    v_and_b32_dpp v12, v30, v4 row_newbcast:8 row_mask:0xf bank_mask:0x3
    v_and_b32_dpp v13, v30, v5 row_newbcast:8 row_mask:0xf bank_mask:0x3
    v_and_b32_dpp v14, v30, v6 row_newbcast:8 row_mask:0xf bank_mask:0x3
    v_and_b32_dpp v15, v30, v7 row_newbcast:8 row_mask:0xf bank_mask:0x3
    v_and_b32_dpp v12, v31, v4 row_newbcast:8 row_mask:0xf bank_mask:0xc
    v_and_b32_dpp v13, v31, v5 row_newbcast:8 row_mask:0xf bank_mask:0xc
    v_and_b32_dpp v14, v31, v6 row_newbcast:8 row_mask:0xf bank_mask:0xc
    v_and_b32_dpp v15, v31, v7 row_newbcast:8 row_mask:0xf bank_mask:0xc
    s_waitcnt vmcnt(2)
    v_mfma_f32_16x16x32_bf16 v[36:39], v[8:11], v[96:99], v[36:39]
    v_mfma_f32_16x16x32_bf16 v[40:43], v[12:15], v[96:99], v[40:43]
    v_and_b32_dpp v8, v28, v4 row_newbcast:9 row_mask:0xf bank_mask:0x3
    v_and_b32_dpp v9, v28, v5 row_newbcast:9 row_mask:0xf bank_mask:0x3
    v_and_b32_dpp v10, v28, v6 row_newbcast:9 row_mask:0xf bank_mask:0x3
    v_and_b32_dpp v11, v28, v7 row_newbcast:9 row_mask:0xf bank_mask:0x3
    v_and_b32_dpp v8, v29, v4 row_newbcast:9 row_mask:0xf bank_mask:0xc
    v_and_b32_dpp v9, v29, v5 row_newbcast:9 row_mask:0xf bank_mask:0xc
    v_and_b32_dpp v10, v29, v6 row_newbcast:9 row_mask:0xf bank_mask:0xc
    v_and_b32_dpp v11, v29, v7 row_newbcast:9 row_mask:0xf bank_mask:0xc
    v_and_b32_dpp v12, v30, v4 row_newbcast:9 row_mask:0xf bank_mask:0x3
    v_and_b32_dpp v13, v30, v5 row_newbcast:9 row_mask:0xf bank_mask:0x3
    v_and_b32_dpp v14, v30, v6 row_newbcast:9 row_mask:0xf bank_mask:0x3
    v_and_b32_dpp v15, v30, v7 row_newbcast:9 row_mask:0xf bank_mask:0x3
    v_and_b32_dpp v12, v31, v4 row_newbcast:9 row_mask:0xf bank_mask:0xc
    v_and_b32_dpp v13, v31, v5 row_newbcast:9 row_mask:0xf bank_mask:0xc
    v_and_b32_dpp v14, v31, v6 row_newbcast:9 row_mask:0xf bank_mask:0xc
    v_and_b32_dpp v15, v31, v7 row_newbcast:9 row_mask:0xf bank_mask:0xc
    s_waitcnt vmcnt(1)
    v_mfma_f32_16x16x32_bf16 v[36:39], v[8:11], v[100:103], v[36:39]
    v_mfma_f32_16x16x32_bf16 v[40:43], v[12:15], v[100:103], v[40:43]
    buffer_load_dword v228, v229, s[44:47], s24 offen sc1
    s_mov_b64 s[32:33], s[30:31]
    s_add_u32 s61, s37, 10240
    buffer_load_dwordx4 v[104:107], v57, s[32:35], s61 offen nt
    buffer_load_dwordx4 v[112:115], v57, s[32:35], s61 offen offset:256 nt
    buffer_load_dwordx4 v[120:123], v57, s[32:35], s61 offen offset:512 nt
    v_lshrrev_b32 v17, 1, v2
    v_mul_u32_u24 v17, 480, v17
    s_mul_i32 s3, s39, 1536
    v_add3_u32 v17, v17, s3, v16
    ds_write_b128 v17, v[36:39] offset:4352
    ds_write_b128 v17, v[40:43] offset:5376
    s_lshl_b32 s3, s39, 9
    v_add_u32 v17, s3, v1
    s_waitcnt lgkmcnt(0)
    s_mov_b64 exec, 1
    ds_add_u32 v59, v60 offset:4244
    s_mov_b64 exec, -1
    s_mov_b32 s70, 0
L_w104:
    ds_read_b32 v244, v59 offset:4244
    s_add_u32 s70, s70, 1
    s_waitcnt lgkmcnt(0)
    v_readfirstlane_b32 s3, v244
    s_cmp_ge_u32 s70, 0x100000
    s_cbranch_scc1 L_w104_ok
    s_cmp_ge_u32 s3, 4
    s_cbranch_scc0 L_w104
L_w104_ok:
    s_mov_b32 exec_hi, 0
    ds_read_b128 v[240:243], v17 offset:4352
    ds_read_b128 v[244:247], v17 offset:6400
    ds_read_b128 v[248:251], v17 offset:8448
    ds_read_b128 v[252:255], v17 offset:10496
    s_lshl_b32 s25, s59, 5
    s_add_u32 s25, s25, s57
    s_lshl_b32 s25, s25, 2
    s_add_u32 s25, s25, s39
    s_lshl_b32 s25, s25, 2
    s_add_u32 s25, s25, s58
    s_lshl_b32 s25, s25, 9
    s_add_u32 s25, s25, 1310720
    s_waitcnt lgkmcnt(2)
    v_pk_add_f32 v[240:241], v[240:241], v[244:245]
    v_pk_add_f32 v[242:243], v[242:243], v[246:247]
    s_waitcnt lgkmcnt(1)
    v_pk_add_f32 v[240:241], v[240:241], v[248:249]
    v_pk_add_f32 v[242:243], v[242:243], v[250:251]
    s_waitcnt lgkmcnt(0)
    v_pk_add_f32 v[240:241], v[240:241], v[252:253]
    v_pk_add_f32 v[242:243], v[242:243], v[254:255]
    v_and_or_b32 v240, v240, v22, v23
    v_and_or_b32 v241, v241, v22, v23
    v_and_or_b32 v242, v242, v22, v23
    v_and_or_b32 v243, v243, v22, v23
    s_waitcnt vmcnt(3)
    v_cmp_ne_u32 vcc, s77, v228
    s_nop 0
    s_and_b32 s38, vcc_lo, 0xff
    s_cmp_eq_u32 s38, 0
    s_cbranch_scc1 L_qs_l
    buffer_store_dwordx4 v[240:243], v1, s[44:47], s25 offen sc1
    s_branch L_qs_e
L_qs_l:
    buffer_store_dwordx4 v[240:243], v1, s[44:47], s25 offen
L_qs_e:
    s_mov_b64 exec, -1
    s_waitcnt vmcnt(3)
    buffer_load_dwordx4 v[128:131], v57, s[32:35], s61 offen offset:768 nt
    s_waitcnt vmcnt(3)
    buffer_load_dwordx4 v[136:139], v57, s[32:35], s61 offen offset:1024 nt
    s_add_u32 s61, s61, 5120
    s_waitcnt vmcnt(3)
    buffer_load_dwordx4 v[108:111], v57, s[32:35], s61 offen nt
    s_cmp_ge_u32 s39, 2
    s_cbranch_scc1 L_qr
    s_lshl_b32 s25, s39, 5
    s_add_u32 s25, s25, s57
    s_lshl_b32 s25, s25, 2
    s_add_u32 s25, s25, s58
    s_lshl_b32 s25, s25, 11
    s_add_u32 s25, s25, 1310720
    s_lshl_b32 s3, s39, 9
    v_add_u32 v17, s3, v1
    s_lshl_b32 s3, s39, 2
    v_mov_b32 v61, s3
    s_mov_b32 s70, 0
    s_waitcnt vmcnt(0)
L_qr_a:
    buffer_load_dwordx4 v[244:247], v1, s[44:47], s25 offen offset:0 sc1
    buffer_load_dwordx4 v[248:251], v1, s[44:47], s25 offen offset:1024 sc1
    s_add_u32 s70, s70, 1
    s_waitcnt vmcnt(0)
    v_xor_b32 v244, v244, v23
    v_xor_b32 v245, v245, v23
    v_xor_b32 v246, v246, v23
    v_xor_b32 v247, v247, v23
    v_xor_b32 v248, v248, v23
    v_xor_b32 v249, v249, v23
    v_xor_b32 v250, v250, v23
    v_xor_b32 v251, v251, v23
    v_or3_b32 v252, v244, v245, v246
    v_or3_b32 v252, v252, v247, v248
    v_or3_b32 v252, v252, v249, v250
    v_or_b32 v252, v252, v251
    v_and_b32 v252, 0xff, v252
    v_cmp_ne_u32 vcc, 0, v252
    s_cmp_ge_u32 s70, 0x40000
    s_cbranch_scc1 L_qr_b
    s_cbranch_vccz L_qr_b
    s_sleep 2
    s_branch L_qr_a
L_qr_b:
    v_pk_add_f32 v[244:245], v[244:245], v[248:249]
    v_pk_add_f32 v[246:247], v[246:247], v[250:251]
    v_mov_b32 v248, v244
    v_mov_b32 v249, v245
    v_mov_b32 v250, v246
    v_mov_b32 v251, v247
    v_permlane32_swap_b32 v244, v248
    v_permlane32_swap_b32 v245, v249
    v_permlane32_swap_b32 v246, v250
    v_permlane32_swap_b32 v247, v251
    v_add_f32 v244, v244, v248
    v_add_f32 v245, v245, v249
    v_add_f32 v246, v246, v250
    v_add_f32 v247, v247, v251
    s_mov_b32 exec_hi, 0
    ds_write_b128 v17, v[244:247] offset:15360
    s_mov_b64 exec, -1
    s_waitcnt lgkmcnt(0)
    s_mov_b64 exec, 1
    ds_add_u32 v61, v60 offset:4224
    s_mov_b64 exec, -1
L_qr:
    s_waitcnt vmcnt(2)
    buffer_load_dwordx4 v[116:119], v57, s[32:35], s61 offen offset:256 nt
    s_waitcnt vmcnt(2)
    buffer_load_dwordx4 v[124:127], v57, s[32:35], s61 offen offset:512 nt
    s_waitcnt vmcnt(2)
    buffer_load_dwordx4 v[132:135], v57, s[32:35], s61 offen offset:768 nt
    s_waitcnt vmcnt(2)
    buffer_load_dwordx4 v[140:143], v57, s[32:35], s61 offen offset:1024 nt
    s_add_u32 s61, s61, 5120
    s_waitcnt vmcnt(2)
    buffer_load_dwordx4 v[144:147], v57, s[32:35], s61 offen nt
    s_waitcnt vmcnt(2)
    buffer_load_dwordx4 v[152:155], v57, s[32:35], s61 offen offset:256 nt
    s_waitcnt vmcnt(2)
    buffer_load_dwordx4 v[160:163], v57, s[32:35], s61 offen offset:512 nt
    s_waitcnt vmcnt(2)
    buffer_load_dwordx4 v[168:171], v57, s[32:35], s61 offen offset:768 nt
    s_waitcnt vmcnt(2)
    buffer_load_dwordx4 v[176:179], v57, s[32:35], s61 offen offset:1024 nt
    s_add_u32 s61, s61, 5120
    s_waitcnt vmcnt(2)
    buffer_load_dwordx4 v[148:151], v57, s[32:35], s61 offen nt
    s_waitcnt vmcnt(2)
    buffer_load_dwordx4 v[156:159], v57, s[32:35], s61 offen offset:256 nt
    s_waitcnt vmcnt(2)
    buffer_load_dwordx4 v[164:167], v57, s[32:35], s61 offen offset:512 nt
    s_waitcnt vmcnt(2)
    buffer_load_dwordx4 v[172:175], v57, s[32:35], s61 offen offset:768 nt
    s_waitcnt vmcnt(2)
    buffer_load_dwordx4 v[180:183], v57, s[32:35], s61 offen offset:1024 nt
    s_add_u32 s61, s61, 5120
    s_waitcnt vmcnt(2)
    buffer_load_dwordx4 v[184:187], v57, s[32:35], s61 offen nt
    s_waitcnt vmcnt(2)
    buffer_load_dwordx4 v[192:195], v57, s[32:35], s61 offen offset:256 nt
    s_waitcnt vmcnt(2)
    buffer_load_dwordx4 v[200:203], v57, s[32:35], s61 offen offset:512 nt
    s_waitcnt vmcnt(2)
    buffer_load_dwordx4 v[208:211], v57, s[32:35], s61 offen offset:768 nt
    s_waitcnt vmcnt(2)
    buffer_load_dwordx4 v[216:219], v57, s[32:35], s61 offen offset:1024 nt
    s_add_u32 s61, s61, 5120
    s_waitcnt vmcnt(2)
    buffer_load_dwordx4 v[188:191], v57, s[32:35], s61 offen nt
    s_waitcnt vmcnt(2)
    buffer_load_dwordx4 v[196:199], v57, s[32:35], s61 offen offset:256 nt
    s_waitcnt vmcnt(2)
    buffer_load_dwordx4 v[204:207], v57, s[32:35], s61 offen offset:512 nt
    s_waitcnt vmcnt(2)
    buffer_load_dwordx4 v[212:215], v57, s[32:35], s61 offen offset:768 nt
    s_waitcnt vmcnt(2)
    buffer_load_dwordx4 v[220:223], v57, s[32:35], s61 offen offset:1024 nt
    s_add_u32 s61, s61, 5120
    s_waitcnt vmcnt(2)
    s_mov_b32 s61, s37
    buffer_load_dwordx4 v[64:67], v57, s[32:35], s61 offen nt
    s_waitcnt vmcnt(2)
    buffer_load_dwordx4 v[72:75], v57, s[32:35], s61 offen offset:256 nt
    s_waitcnt vmcnt(2)
    buffer_load_dwordx4 v[80:83], v57, s[32:35], s61 offen offset:512 nt
    s_waitcnt vmcnt(2)
    buffer_load_dwordx4 v[88:91], v57, s[32:35], s61 offen offset:768 nt
    s_waitcnt vmcnt(2)
    buffer_load_dwordx4 v[96:99], v57, s[32:35], s61 offen offset:1024 nt
    s_add_u32 s61, s61, 5120
    s_waitcnt vmcnt(2)
    buffer_load_dwordx4 v[68:71], v57, s[32:35], s61 offen nt
    s_waitcnt vmcnt(2)
    buffer_load_dwordx4 v[76:79], v57, s[32:35], s61 offen offset:256 nt
    s_waitcnt vmcnt(2)
    buffer_load_dwordx4 v[84:87], v57, s[32:35], s61 offen offset:512 nt
    s_waitcnt vmcnt(2)
    buffer_load_dwordx4 v[92:95], v57, s[32:35], s61 offen offset:768 nt
    s_waitcnt vmcnt(2)
    buffer_load_dwordx4 v[100:103], v57, s[32:35], s61 offen offset:1024 nt
    s_add_u32 s61, s61, 5120
    s_waitcnt vmcnt(0)
    v_mov_b32 v17, 0xffff
    v_lshrrev_b32 v18, 2, v3
    v_cmp_eq_u32 vcc, 0, v18
    s_nop 1
    v_cndmask_b32_e32 v4, 0, v17, vcc
    v_lshlrev_b32 v6, 16, v4
    v_cmp_eq_u32 vcc, 1, v18
    s_nop 1
    v_cndmask_b32_e32 v5, 0, v17, vcc
    v_lshlrev_b32 v7, 16, v5
    v_and_b32 v18, 3, v3
    v_mul_u32_u24 v61, 0x5555, v18
    v_lshlrev_b32 v18, 5, v18
    v_lshl_add_u32 v18, v2, 3, v18
    s_lshl_b32 s3, s39, 7
    v_add_u32 v18, s3, v18
    v_mov_b32 v36, 0
    v_mov_b32 v37, 0
    v_mov_b32 v38, 0
    v_mov_b32 v39, 0
    v_mov_b32 v40, 0
    v_mov_b32 v41, 0
    v_mov_b32 v42, 0
    v_mov_b32 v43, 0
    v_mov_b32 v44, 0
    v_mov_b32 v45, 0
    v_mov_b32 v46, 0
    v_mov_b32 v47, 0
    v_mov_b32 v48, 0
    v_mov_b32 v49, 0
    v_mov_b32 v50, 0
    v_mov_b32 v51, 0
    v_mov_b32 v52, 0
    v_mov_b32 v53, 0
    v_mov_b32 v54, 0
    v_mov_b32 v55, 0
    s_lshl_b32 s71, s59, 2
    s_add_u32 s71, s71, s58
    s_mul_i32 s71, s71, 20
    s_add_u32 s71, s71, s57
    s_lshl_b32 s71, s71, 12
    s_mov_b32 s52, s48
    s_mov_b32 s53, s49
    s_mov_b32 s54, 10240
    s_mov_b32 s55, 0x20000
    s_mul_i32 s36, s58, 2560
    s_mul_i32 s3, s59, 1280
    s_add_u32 s36, s36, s3
    s_lshl_b32 s3, s57, 6
    s_add_u32 s36, s36, s3
    v_lshrrev_b32 v232, 1, v1
    v_mov_b32 v233, s77
    s_mov_b32 s73, 0
    s_cmp_lt_u32 s57, 20
    s_cselect_b32 s37, s39, 1
    s_cmp_lg_u32 s39, 1
    s_cbranch_scc1 L_ctl_end
    s_lshl_b32 s8, s26, 8
    s_add_u32 s8, s8, 1839104
    s_lshr_b32 s9, s2, 3
    s_lshl_b32 s9, s9, 2
    s_add_u32 s9, s9, s8
    s_mov_b32 s10, 7864
    s_bitcmp0_b32 s26, 0
    s_cselect_b32 s10, 17039, s10
    v_lshrrev_b32 v224, 2, v1
    s_lshl_b32 s23, s77, 12
    s_mov_b32 s11, 0
    s_mov_b32 s70, 0
L_ctl:
    ds_read_b128 v[244:247], v59 offset:4256
    ds_read_b32 v248, v224 offset:4256
    s_waitcnt lgkmcnt(0)
    v_add3_u32 v244, v244, v245, v246
    v_add_u32 v244, v244, v247
    v_or_b32 v245, s23, v244
    v_readfirstlane_b32 s12, v244
    s_mov_b64 exec, 1
    buffer_store_dword v245, v59, s[44:47], s9 offen
    s_mov_b32 exec_lo, -1
    buffer_load_dword v246, v224, s[44:47], s8 offen sc1
    s_add_u32 s13, s12, s11
    s_lshl_b32 s13, s13, 4
    s_lshl_b32 s14, s12, 5
    s_sub_i32 s13, s14, s13
    s_cmp_eq_u32 s11, 0
    s_cselect_b32 s15, 0, -1
    s_mov_b32 s11, s12
    s_waitcnt vmcnt(0)
    v_xor_b32 v246, s23, v246
    v_cmp_gt_u32 vcc, 0x1000, v246
    s_nop 0
    v_add_u32_dpp v246, v246, v246 row_ror:8 row_mask:0xf bank_mask:0xf
    s_nop 1
    v_add_u32_dpp v246, v246, v246 row_ror:4 row_mask:0xf bank_mask:0xf
    s_nop 1
    v_add_u32_dpp v246, v246, v246 row_ror:2 row_mask:0xf bank_mask:0xf
    s_nop 1
    v_add_u32_dpp v246, v246, v246 row_ror:1 row_mask:0xf bank_mask:0xf
    s_and_b32 s15, s15, vcc_lo
    v_readlane_b32 s16, v246, 0
    v_readlane_b32 s17, v246, 16
    v_lshlrev_b32 v248, 7, v248
    s_add_u32 s16, s16, s17
    s_add_i32 s16, s16, s13
    s_cmp_eq_u32 s15, -1
    s_cselect_b32 s17, 61, 0
    v_sub_u32 v248, s16, v248
    v_mul_i32_i24 v248, s17, v248
    v_add_u32 v248, s10, v248
    v_max_i32 v248, 0, v248
    v_min_i32 v248, 0xffff, v248
    v_lshlrev_b32 v248, 16, v248
    s_mov_b64 exec, 15
    ds_write_b32 v224, v248 offset:4272
    s_mov_b64 exec, -1
    s_add_u32 s70, s70, 1
    s_cmp_ge_u32 s70, 0x10000
    s_cbranch_scc1 L_ctl_end
    s_cmp_ge_u32 s12, 1920
    s_cbranch_scc1 L_ctl_end
    s_sleep 16
    s_branch L_ctl
L_ctl_end:
    s_cmp_lg_u32 s39, 0
    s_cbranch_scc1 L_vs105
    s_cmp_lg_u32 s59, 1
    s_cbranch_scc1 L_vs105
    s_mov_b32 s70, 0
L_m106:
    ds_read_b128 v[244:247], v59 offset:4096
    ds_read_b128 v[248:251], v59 offset:4112
    s_add_u32 s70, s70, 1
    s_waitcnt lgkmcnt(0)
    v_min3_u32 v252, v245, v247, v249
    v_min3_u32 v252, v252, v251, v251
    s_cmp_ge_u32 s70, 0x100000
    v_readfirstlane_b32 s3, v252
    s_cbranch_scc1 L_m106_ok
    s_cmp_lg_u32 s3, 0
    s_cbranch_scc1 L_m106_ok
    s_sleep 4
    s_branch L_m106
L_m106_ok:
    v_max3_f32 v224, v244, v246, v248
    v_max3_f32 v224, v224, v250, v250
    v_sub_f32 v244, v244, v224
    v_sub_f32 v246, v246, v224
    v_sub_f32 v248, v248, v224
    v_sub_f32 v250, v250, v224
    v_exp_f32 v244, v244
    v_exp_f32 v246, v246
    v_exp_f32 v248, v248
    v_exp_f32 v250, v250
    v_mul_f32 v226, v244, v245
    v_fmac_f32 v226, v246, v247
    v_fmac_f32 v226, v248, v249
    v_fmac_f32 v226, v250, v251
    v_lshlrev_b32 v225, 8, v224
    v_lshlrev_b32 v227, 8, v226
    v_add_u32 v17, 0, v1
    v_and_or_b32 v240, v224, v22, v23
    v_and_or_b32 v241, v225, v22, v23
    v_and_or_b32 v242, v226, v22, v23
    v_and_or_b32 v243, v227, v22, v23
    s_mov_b32 s70, 0
L_w107:
    ds_read_b32 v244, v59 offset:4232
    s_add_u32 s70, s70, 1
    s_waitcnt lgkmcnt(0)
    v_readfirstlane_b32 s3, v244
    s_cmp_ge_u32 s70, 0x100000
    s_cbranch_scc1 L_w107_ok
    s_cmp_ge_u32 s3, 4
    s_cbranch_scc1 L_w107_ok
    s_sleep 1
    s_branch L_w107
L_w107_ok:
    s_mov_b32 exec_hi, 0
    ds_read_b128 v[240:243], v17
    ds_read_b128 v[244:247], v17 offset:512
    ds_read_b128 v[248:251], v17 offset:1024
    ds_read_b128 v[252:255], v17 offset:1536
    s_waitcnt lgkmcnt(2)
    v_pk_add_f32 v[240:241], v[240:241], v[244:245]
    v_pk_add_f32 v[242:243], v[242:243], v[246:247]
    s_waitcnt lgkmcnt(1)
    v_pk_add_f32 v[240:241], v[240:241], v[248:249]
    v_pk_add_f32 v[242:243], v[242:243], v[250:251]
    s_waitcnt lgkmcnt(0)
    v_pk_add_f32 v[240:241], v[240:241], v[252:253]
    v_pk_add_f32 v[242:243], v[242:243], v[254:255]
    v_and_or_b32 v240, v240, v22, v23
    v_and_or_b32 v241, v241, v22, v23
    v_and_or_b32 v242, v242, v22, v23
    v_and_or_b32 v243, v243, v22, v23
    s_mov_b32 exec_hi, 1
    s_cmp_eq_u32 s38, 0
    s_cbranch_scc1 L_vs105_l
    buffer_store_dwordx4 v[240:243], v1, s[44:47], s29 offen sc1
    s_branch L_vs105_e
L_vs105_l:
    buffer_store_dwordx4 v[240:243], v1, s[44:47], s29 offen
L_vs105_e:
    s_mov_b64 exec, -1
    s_waitcnt vmcnt(0)
L_vs105:
    s_cmp_lg_u32 s39, 0
    s_cbranch_scc1 L_vr108
    s_cmp_lg_u32 s59, 0
    s_cbranch_scc1 L_vr108
    s_mov_b32 s70, 0
L_m109:
    ds_read_b128 v[244:247], v59 offset:4160
    ds_read_b128 v[248:251], v59 offset:4176
    s_add_u32 s70, s70, 1
    s_waitcnt lgkmcnt(0)
    v_min3_u32 v252, v245, v247, v249
    v_min3_u32 v252, v252, v251, v251
    s_cmp_ge_u32 s70, 0x100000
    v_readfirstlane_b32 s3, v252
    s_cbranch_scc1 L_m109_ok
    s_cmp_lg_u32 s3, 0
    s_cbranch_scc1 L_m109_ok
    s_sleep 16
    s_branch L_m109
L_m109_ok:
    s_mov_b32 s70, 0
L_m110:
    ds_read_b128 v[244:247], v59 offset:4096
    ds_read_b128 v[248:251], v59 offset:4112
    s_add_u32 s70, s70, 1
    s_waitcnt lgkmcnt(0)
    v_min3_u32 v252, v245, v247, v249
    v_min3_u32 v252, v252, v251, v251
    s_cmp_ge_u32 s70, 0x100000
    v_readfirstlane_b32 s3, v252
    s_cbranch_scc1 L_m110_ok
    s_cmp_lg_u32 s3, 0
    s_cbranch_scc1 L_m110_ok
    s_sleep 4
    s_branch L_m110
L_m110_ok:
    v_max3_f32 v224, v244, v246, v248
    v_max3_f32 v224, v224, v250, v250
    v_sub_f32 v244, v244, v224
    v_sub_f32 v246, v246, v224
    v_sub_f32 v248, v248, v224
    v_sub_f32 v250, v250, v224
    v_exp_f32 v244, v244
    v_exp_f32 v246, v246
    v_exp_f32 v248, v248
    v_exp_f32 v250, v250
    v_mul_f32 v225, v244, v245
    v_fmac_f32 v225, v246, v247
    v_fmac_f32 v225, v248, v249
    v_fmac_f32 v225, v250, v251
    s_mov_b32 exec_hi, 1
    v_add_u32 v17, 14592, v1
    s_mov_b32 s70, 0
L_vr108_a:
    buffer_load_dwordx4 v[244:247], v1, s[44:47], s28 offen sc1
    s_add_u32 s70, s70, 1
    s_waitcnt vmcnt(0)
    v_xor_b32 v244, v244, v23
    v_xor_b32 v245, v245, v23
    v_xor_b32 v246, v246, v23
    v_xor_b32 v247, v247, v23
    v_or3_b32 v248, v244, v245, v246
    v_or_b32 v248, v248, v247
    v_and_b32 v248, 0xff, v248
    v_cmp_ne_u32 vcc, 0, v248
    s_cmp_ge_u32 s70, 0x40000
    s_cbranch_scc1 L_vr108_b
    s_cbranch_vccz L_vr108_b
    s_sleep 2
    s_branch L_vr108_a
L_vr108_b:
    v_readlane_b32 s24, v244, 32
    v_readlane_b32 s25, v245, 32
    v_readlane_b32 s26, v246, 32
    v_readlane_b32 s27, v247, 32
    s_bfe_u32 s25, s25, 0x80008
    s_bfe_u32 s27, s27, 0x80008
    s_or_b32 s24, s24, s25
    s_or_b32 s26, s26, s27
    v_max_f32 v226, s24, v224
    v_sub_f32 v224, v224, v226
    v_sub_f32 v226, s24, v226
    v_exp_f32 v224, v224
    v_exp_f32 v226, v226
    v_mul_f32 v225, v224, v225
    v_fma_f32 v225, s26, v226, v225
    v_rcp_f32 v225, v225
    s_mov_b32 exec_hi, 0
    v_mul_f32 v226, v226, v225
    v_mul_f32 v224, v224, v225
    v_mul_f32 v244, v244, v226
    v_mul_f32 v245, v245, v226
    v_mul_f32 v246, v246, v226
    v_mul_f32 v247, v247, v226
    ds_write_b32 v59, v224 offset:4240
    ds_write_b128 v17, v[244:247]
    s_mov_b64 exec, -1
L_vr108:
    s_cmp_lg_u32 s39, 0
    s_cbranch_scc1 L_vs111
    s_cmp_lg_u32 s59, 0
    s_cbranch_scc1 L_vs111
    s_mov_b32 s70, 0
L_m112:
    ds_read_b128 v[244:247], v59 offset:4160
    ds_read_b128 v[248:251], v59 offset:4176
    s_add_u32 s70, s70, 1
    s_waitcnt lgkmcnt(0)
    v_min3_u32 v252, v245, v247, v249
    v_min3_u32 v252, v252, v251, v251
    s_cmp_ge_u32 s70, 0x100000
    v_readfirstlane_b32 s3, v252
    s_cbranch_scc1 L_m112_ok
    s_cmp_lg_u32 s3, 0
    s_cbranch_scc1 L_m112_ok
    s_sleep 4
    s_branch L_m112
L_m112_ok:
    v_max3_f32 v224, v244, v246, v248
    v_max3_f32 v224, v224, v250, v250
    v_sub_f32 v244, v244, v224
    v_sub_f32 v246, v246, v224
    v_sub_f32 v248, v248, v224
    v_sub_f32 v250, v250, v224
    v_exp_f32 v244, v244
    v_exp_f32 v246, v246
    v_exp_f32 v248, v248
    v_exp_f32 v250, v250
    v_mul_f32 v226, v244, v245
    v_fmac_f32 v226, v246, v247
    v_fmac_f32 v226, v248, v249
    v_fmac_f32 v226, v250, v251
    v_lshlrev_b32 v225, 8, v224
    v_lshlrev_b32 v227, 8, v226
    v_add_u32 v17, 0, v1
    v_and_or_b32 v240, v224, v22, v23
    v_and_or_b32 v241, v225, v22, v23
    v_and_or_b32 v242, v226, v22, v23
    v_and_or_b32 v243, v227, v22, v23
    s_mov_b32 s70, 0
L_w113:
    ds_read_b32 v244, v59 offset:4232
    s_add_u32 s70, s70, 1
    s_waitcnt lgkmcnt(0)
    v_readfirstlane_b32 s3, v244
    s_cmp_ge_u32 s70, 0x100000
    s_cbranch_scc1 L_w113_ok
    s_cmp_ge_u32 s3, 4
    s_cbranch_scc1 L_w113_ok
    s_sleep 1
    s_branch L_w113
L_w113_ok:
    s_mov_b32 exec_hi, 0
    ds_read_b128 v[240:243], v17
    ds_read_b128 v[244:247], v17 offset:512
    ds_read_b128 v[248:251], v17 offset:1024
    ds_read_b128 v[252:255], v17 offset:1536
    s_waitcnt lgkmcnt(2)
    v_pk_add_f32 v[240:241], v[240:241], v[244:245]
    v_pk_add_f32 v[242:243], v[242:243], v[246:247]
    s_waitcnt lgkmcnt(1)
    v_pk_add_f32 v[240:241], v[240:241], v[248:249]
    v_pk_add_f32 v[242:243], v[242:243], v[250:251]
    s_waitcnt lgkmcnt(0)
    v_pk_add_f32 v[240:241], v[240:241], v[252:253]
    v_pk_add_f32 v[242:243], v[242:243], v[254:255]
    v_and_or_b32 v240, v240, v22, v23
    v_and_or_b32 v241, v241, v22, v23
    v_and_or_b32 v242, v242, v22, v23
    v_and_or_b32 v243, v243, v22, v23
    s_mov_b32 exec_hi, 1
    s_cmp_eq_u32 s38, 0
    s_cbranch_scc1 L_vs111_l
    buffer_store_dwordx4 v[240:243], v1, s[44:47], s29 offen sc1
    s_branch L_vs111_e
L_vs111_l:
    buffer_store_dwordx4 v[240:243], v1, s[44:47], s29 offen
L_vs111_e:
    s_mov_b64 exec, -1
    s_waitcnt vmcnt(0)
L_vs111:
    s_cmp_lg_u32 s39, 0
    s_cbranch_scc1 L_vr114
    s_cmp_lg_u32 s59, 1
    s_cbranch_scc1 L_vr114
    s_mov_b32 s70, 0
L_m115:
    ds_read_b128 v[244:247], v59 offset:4160
    ds_read_b128 v[248:251], v59 offset:4176
    s_add_u32 s70, s70, 1
    s_waitcnt lgkmcnt(0)
    v_min3_u32 v252, v245, v247, v249
    v_min3_u32 v252, v252, v251, v251
    s_cmp_ge_u32 s70, 0x100000
    v_readfirstlane_b32 s3, v252
    s_cbranch_scc1 L_m115_ok
    s_cmp_lg_u32 s3, 0
    s_cbranch_scc1 L_m115_ok
    s_sleep 4
    s_branch L_m115
L_m115_ok:
    v_max3_f32 v224, v244, v246, v248
    v_max3_f32 v224, v224, v250, v250
    v_sub_f32 v244, v244, v224
    v_sub_f32 v246, v246, v224
    v_sub_f32 v248, v248, v224
    v_sub_f32 v250, v250, v224
    v_exp_f32 v244, v244
    v_exp_f32 v246, v246
    v_exp_f32 v248, v248
    v_exp_f32 v250, v250
    v_mul_f32 v225, v244, v245
    v_fmac_f32 v225, v246, v247
    v_fmac_f32 v225, v248, v249
    v_fmac_f32 v225, v250, v251
    s_mov_b32 s70, 0
L_w116:
    ds_read_b32 v244, v59 offset:4236
    s_add_u32 s70, s70, 1
    s_waitcnt lgkmcnt(0)
    v_readfirstlane_b32 s3, v244
    s_cmp_ge_u32 s70, 0x100000
    s_cbranch_scc1 L_w116_ok
    s_cmp_ge_u32 s3, 1
    s_cbranch_scc1 L_w116_ok
    s_sleep 4
    s_branch L_w116
L_w116_ok:
    s_mov_b32 exec_hi, 1
    v_add_u32 v17, 14592, v1
    s_mov_b32 s70, 0
L_vr114_a:
    buffer_load_dwordx4 v[244:247], v1, s[44:47], s28 offen sc1
    s_add_u32 s70, s70, 1
    s_waitcnt vmcnt(0)
    v_xor_b32 v244, v244, v23
    v_xor_b32 v245, v245, v23
    v_xor_b32 v246, v246, v23
    v_xor_b32 v247, v247, v23
    v_or3_b32 v248, v244, v245, v246
    v_or_b32 v248, v248, v247
    v_and_b32 v248, 0xff, v248
    v_cmp_ne_u32 vcc, 0, v248
    s_cmp_ge_u32 s70, 0x40000
    s_cbranch_scc1 L_vr114_b
    s_cbranch_vccz L_vr114_b
    s_sleep 2
    s_branch L_vr114_a
L_vr114_b:
    v_readlane_b32 s24, v244, 32
    v_readlane_b32 s25, v245, 32
    v_readlane_b32 s26, v246, 32
    v_readlane_b32 s27, v247, 32
    s_bfe_u32 s25, s25, 0x80008
    s_bfe_u32 s27, s27, 0x80008
    s_or_b32 s24, s24, s25
    s_or_b32 s26, s26, s27
    v_max_f32 v226, s24, v224
    v_sub_f32 v224, v224, v226
    v_sub_f32 v226, s24, v226
    v_exp_f32 v224, v224
    v_exp_f32 v226, v226
    v_mul_f32 v225, v224, v225
    v_fma_f32 v225, s26, v226, v225
    v_rcp_f32 v225, v225
    s_mov_b32 exec_hi, 0
    v_mul_f32 v226, v226, v225
    v_mul_f32 v224, v224, v225
    v_mul_f32 v244, v244, v226
    v_mul_f32 v245, v245, v226
    v_mul_f32 v246, v246, v226
    v_mul_f32 v247, v247, v226
    ds_write_b32 v59, v224 offset:4240
    ds_write_b128 v17, v[244:247]
    s_mov_b64 exec, -1
L_vr114:
    s_waitcnt lgkmcnt(0)
    s_barrier
L_t1:
    ds_read_b64 v[234:235], v18 offset:2048
    ds_read_b64 v[236:237], v18 offset:2560
    ds_read_b64 v[238:239], v18 offset:3072
    ds_read_b64 v[240:241], v18 offset:3584
    ds_read_b64 v[28:29], v18 offset:14592
    ds_read_b32 v30, v59 offset:4240
    s_waitcnt lgkmcnt(4)
    v_pk_add_f32 v[234:235], v[234:235], v[236:237]
    s_waitcnt lgkmcnt(2)
    v_pk_add_f32 v[238:239], v[238:239], v[240:241]
    v_pk_add_f32 v[234:235], v[234:235], v[238:239]
    s_waitcnt lgkmcnt(0)
    v_fma_f32 v234, v234, v30, v28
    v_fma_f32 v235, v235, v30, v29
    v_cvt_pk_bf16_f32 v234, v234, v235
    s_nop 1
    v_and_b32_dpp v8, v234, v4 row_newbcast:0 row_mask:0xf bank_mask:0xf
    v_and_b32_dpp v9, v234, v5 row_newbcast:0 row_mask:0xf bank_mask:0xf
    v_and_b32_dpp v10, v234, v6 row_newbcast:0 row_mask:0xf bank_mask:0xf
    v_and_b32_dpp v11, v234, v7 row_newbcast:0 row_mask:0xf bank_mask:0xf
    v_and_b32_dpp v12, v234, v4 row_newbcast:1 row_mask:0xf bank_mask:0xf
    v_and_b32_dpp v13, v234, v5 row_newbcast:1 row_mask:0xf bank_mask:0xf
    v_and_b32_dpp v14, v234, v6 row_newbcast:1 row_mask:0xf bank_mask:0xf
    v_and_b32_dpp v15, v234, v7 row_newbcast:1 row_mask:0xf bank_mask:0xf
    v_smfmac_f32_16x16x64_bf16 v[36:39], v[8:11], v[64:71], v61
    v_smfmac_f32_16x16x64_bf16 v[40:43], v[8:11], v[72:79], v61
    v_smfmac_f32_16x16x64_bf16 v[44:47], v[8:11], v[80:87], v61
    v_smfmac_f32_16x16x64_bf16 v[48:51], v[8:11], v[88:95], v61
    v_smfmac_f32_16x16x64_bf16 v[52:55], v[8:11], v[96:103], v61
    v_and_b32_dpp v8, v234, v4 row_newbcast:2 row_mask:0xf bank_mask:0xf
    v_and_b32_dpp v9, v234, v5 row_newbcast:2 row_mask:0xf bank_mask:0xf
    v_and_b32_dpp v10, v234, v6 row_newbcast:2 row_mask:0xf bank_mask:0xf
    v_and_b32_dpp v11, v234, v7 row_newbcast:2 row_mask:0xf bank_mask:0xf
    v_smfmac_f32_16x16x64_bf16 v[36:39], v[12:15], v[104:111], v61
    v_smfmac_f32_16x16x64_bf16 v[40:43], v[12:15], v[112:119], v61
    v_smfmac_f32_16x16x64_bf16 v[44:47], v[12:15], v[120:127], v61
    v_smfmac_f32_16x16x64_bf16 v[48:51], v[12:15], v[128:135], v61
    v_smfmac_f32_16x16x64_bf16 v[52:55], v[12:15], v[136:143], v61
    v_and_b32_dpp v12, v234, v4 row_newbcast:3 row_mask:0xf bank_mask:0xf
    v_and_b32_dpp v13, v234, v5 row_newbcast:3 row_mask:0xf bank_mask:0xf
    v_and_b32_dpp v14, v234, v6 row_newbcast:3 row_mask:0xf bank_mask:0xf
    v_and_b32_dpp v15, v234, v7 row_newbcast:3 row_mask:0xf bank_mask:0xf
    v_smfmac_f32_16x16x64_bf16 v[36:39], v[8:11], v[144:151], v61
    v_smfmac_f32_16x16x64_bf16 v[40:43], v[8:11], v[152:159], v61
    v_smfmac_f32_16x16x64_bf16 v[44:47], v[8:11], v[160:167], v61
    v_smfmac_f32_16x16x64_bf16 v[48:51], v[8:11], v[168:175], v61
    v_smfmac_f32_16x16x64_bf16 v[52:55], v[8:11], v[176:183], v61
    v_smfmac_f32_16x16x64_bf16 v[36:39], v[12:15], v[184:191], v61
    v_smfmac_f32_16x16x64_bf16 v[40:43], v[12:15], v[192:199], v61
    v_smfmac_f32_16x16x64_bf16 v[44:47], v[12:15], v[200:207], v61
    v_smfmac_f32_16x16x64_bf16 v[48:51], v[12:15], v[208:215], v61
    v_smfmac_f32_16x16x64_bf16 v[52:55], v[12:15], v[216:223], v61
    s_mov_b32 exec_hi, 0
    s_nop 2
    ds_write_b128 v19, v[36:39] offset:4352
    ds_write_b128 v19, v[40:43] offset:4864
    ds_write_b128 v19, v[44:47] offset:5376
    ds_write_b128 v19, v[48:51] offset:5888
    ds_write_b128 v19, v[52:55] offset:6400
    s_mov_b64 exec, s[74:75]
    s_waitcnt lgkmcnt(0)
    s_barrier
    s_cbranch_execz L_done
L_t2:
    ds_read_b128 v[64:67], v20 offset:4352
    ds_read_b128 v[68:71], v20 offset:6912
    ds_read_b128 v[72:75], v20 offset:9472
    ds_read_b128 v[76:79], v20 offset:12032
    s_waitcnt lgkmcnt(2)
    v_pk_add_f32 v[64:65], v[64:65], v[68:69]
    v_pk_add_f32 v[66:67], v[66:67], v[70:71]
    s_waitcnt lgkmcnt(0)
    v_pk_add_f32 v[72:73], v[72:73], v[76:77]
    v_pk_add_f32 v[74:75], v[74:75], v[78:79]
    v_pk_add_f32 v[64:65], v[64:65], v[72:73]
    v_pk_add_f32 v[66:67], v[66:67], v[74:75]
    v_and_or_b32 v64, v64, v22, v23
    v_and_or_b32 v65, v65, v22, v23
    v_and_or_b32 v66, v66, v22, v23
    v_and_or_b32 v67, v67, v22, v23
    buffer_store_dwordx4 v[64:67], v21, s[44:47], s72 offen sc1
    s_cmp_lg_u32 s37, 0
    s_cbranch_scc1 L_done
    s_waitcnt vmcnt(0)
L_poll:
    buffer_load_dwordx4 v[80:83], v1, s[44:47], s71 offen offset:0 sc1
    buffer_load_dwordx4 v[84:87], v1, s[44:47], s71 offen offset:1024 sc1
    buffer_load_dwordx4 v[88:91], v1, s[44:47], s71 offen offset:2048 sc1
    buffer_load_dwordx4 v[92:95], v1, s[44:47], s71 offen offset:3072 sc1
L_t3:
    s_waitcnt vmcnt(3)
    v_xor_b32 v80, s76, v80
    v_xor_b32 v81, s76, v81
    v_xor_b32 v82, s76, v82
    v_xor_b32 v83, s76, v83
    v_or_b32 v17, v80, v81
    v_or3_b32 v17, v17, v82, v83
    s_waitcnt vmcnt(2)
    v_xor_b32 v84, s76, v84
    v_xor_b32 v85, s76, v85
    v_xor_b32 v86, s76, v86
    v_xor_b32 v87, s76, v87
    v_or3_b32 v17, v17, v84, v85
    v_or3_b32 v17, v17, v86, v87
    v_pk_add_f32 v[112:113], v[80:81], v[84:85]
    v_pk_add_f32 v[114:115], v[82:83], v[86:87]
    s_waitcnt vmcnt(1)
    v_xor_b32 v88, s76, v88
    v_xor_b32 v89, s76, v89
    v_xor_b32 v90, s76, v90
    v_xor_b32 v91, s76, v91
    v_or3_b32 v17, v17, v88, v89
    v_or3_b32 v17, v17, v90, v91
    v_pk_add_f32 v[112:113], v[112:113], v[88:89]
    v_pk_add_f32 v[114:115], v[114:115], v[90:91]
    s_waitcnt vmcnt(0)
    v_xor_b32 v92, s76, v92
    v_xor_b32 v93, s76, v93
    v_xor_b32 v94, s76, v94
    v_xor_b32 v95, s76, v95
    v_or3_b32 v17, v17, v92, v93
    v_or3_b32 v17, v17, v94, v95
    v_pk_add_f32 v[112:113], v[112:113], v[92:93]
    v_pk_add_f32 v[114:115], v[114:115], v[94:95]
    v_and_b32 v17, 0xff, v17
    v_cmp_ne_u32 vcc, 0, v17
    s_add_u32 s73, s73, 1
    s_cmp_ge_u32 s73, 0x40000
    s_cbranch_scc1 L_poll_ok
    s_cbranch_vccnz L_poll
L_poll_ok:
    v_add_f32_dpp v112, v112, v112 row_ror:8 row_mask:0xf bank_mask:0xf
    v_add_f32_dpp v113, v113, v113 row_ror:8 row_mask:0xf bank_mask:0xf
    v_add_f32_dpp v114, v114, v114 row_ror:8 row_mask:0xf bank_mask:0xf
    v_add_f32_dpp v115, v115, v115 row_ror:8 row_mask:0xf bank_mask:0xf
    v_mov_b32 v116, v112
    v_mov_b32 v117, v113
    v_mov_b32 v118, v114
    v_mov_b32 v119, v115
    v_permlane16_swap_b32 v112, v116
    v_permlane16_swap_b32 v113, v117
    v_permlane16_swap_b32 v114, v118
    v_permlane16_swap_b32 v115, v119
    v_add_f32 v112, v112, v116
    v_add_f32 v113, v113, v117
    v_add_f32 v114, v114, v118
    v_add_f32 v115, v115, v119
    v_mov_b32 v116, v112
    v_mov_b32 v117, v113
    v_mov_b32 v118, v114
    v_mov_b32 v119, v115
    v_permlane32_swap_b32 v112, v116
    v_permlane32_swap_b32 v113, v117
    v_permlane32_swap_b32 v114, v118
    v_permlane32_swap_b32 v115, v119
    v_add_f32 v112, v112, v116
    v_add_f32 v113, v113, v117
    v_add_f32 v114, v114, v118
    v_add_f32 v115, v115, v119
    v_cvt_pk_bf16_f32 v112, v112, v113
    v_cvt_pk_bf16_f32 v113, v114, v115
    s_mov_b64 exec, 0xff
    buffer_store_dwordx2 v[112:113], v232, s[52:55], s36 offen
    s_lshl_b32 s3, s62, 1
    s_add_u32 s3, s3, s59
    s_cmp_lg_u32 s3, 1
    s_cbranch_scc1 L_done
    s_mov_b64 exec, 1
    buffer_store_dword v233, v59, s[44:47], s78 offen sc1
L_done:
    s_endpgm
.section .rodata,"a"
.p2align 6
.amdhsa_kernel concat_heads__mha_block_cached__gqa_block_cached__decode_kernel
  .amdhsa_next_free_vgpr 256
  .amdhsa_next_free_sgpr 100
  .amdhsa_accum_offset 256
  .amdhsa_group_segment_fixed_size 0
  .amdhsa_kernarg_size 104
  .amdhsa_user_sgpr_count 2
  .amdhsa_user_sgpr_kernarg_segment_ptr 1
  .amdhsa_system_sgpr_workgroup_id_x 1
.end_amdhsa_kernel
```
